```python
import torch

def _softmax(x, axis=-1):
    return torch.softmax(x, dim=axis)
def _gelu(x):
    return torch.nn.functional.gelu(x, approximate="tanh")
def _silu(x):
    return torch.nn.functional.silu(x)
def _sigmoid(x):
    return torch.sigmoid(x)
def _layernorm(x, axis=-1, eps=1e-5):
    m = x.mean(dim=axis, keepdim=True)
    v = x.var(dim=axis, keepdim=True, unbiased=False)
    return (x - m) / torch.sqrt(v + eps)
def _scatter_add(tgt, idx, src, axis=0):
    return tgt.clone().index_add_(axis, idx, src)
def _segment_sum(src, seg, n):
    out = torch.zeros((n,) + src.shape[1:], dtype=src.dtype)
    return out.index_add_(0, seg, src)
def _pad(x, pw):
    flat = tuple(v for pair in reversed(pw) for v in pair)
    return torch.nn.functional.pad(x, flat)

kernel_name = 'gather_scatter__cheap_equivariant_egnn__graph'

def setup_inputs():

    _w = (lambda a: (lambda t: t.to(torch.bfloat16) if t.is_floating_point() else t)(torch.as_tensor(a)))
    N, deg, D, De = 12500, 32, 128, max(0, 1)
    E = N * deg
    return {
        "h": _w((lambda *s: torch.randn(*s, dtype=torch.bfloat16) * 0.1)(N, D)),
        "pos": _w((lambda *s: torch.randn(*s, dtype=torch.bfloat16) * 0.8)(N, 3)),
        "e_attr": _w((lambda *s: torch.randn(*s, dtype=torch.bfloat16) * 0.8)(E, De)),
        "src": _w((lambda lo, hi, *s: torch.randint(lo, hi, s))(0, N, E).to(torch.int64)),
        "dst": _w((lambda lo, hi, *s: torch.randint(lo, hi, s))(0, N, E).to(torch.int64)),
        "w_e": _w(0.1 * (lambda *s: torch.randn(*s, dtype=torch.bfloat16) * 0.8)(2 * D + 1 + De, D)),
        "w_x": _w(0.1 * (lambda *s: torch.randn(*s, dtype=torch.bfloat16) * 0.1)(D, 1)),
        "w_h": _w(0.1 * (lambda *s: torch.randn(*s, dtype=torch.bfloat16) * 0.1)(2 * D, D)),
    }

def reference(h, pos, e_attr, src, dst, w_e, w_x, w_h):
    N, D = h.shape[0], h.shape[1]
    diff = pos[dst] - pos[src]
    dist2 = torch.sum(diff * diff, axis=-1, keepdims=True)
    e_in = torch.concatenate([h[dst], h[src], dist2, e_attr], axis=-1)
    m_ij = _silu(e_in @ w_e)
    coord_scale = m_ij @ w_x
    pos_new = pos + _segment_sum(diff * coord_scale, dst, N)
    m_i = _segment_sum(m_ij, dst, N)
    h_new = h + _silu(torch.concatenate([h, m_i], axis=-1) @ w_h)
    return h_new, pos_new
```

```asm
; @launch grid=(256,1,1) block=(1024,1,1) lds=163840
.amdgcn_target "amdgcn-amd-amdhsa--gfx950"
.text
.globl gather_scatter__cheap_equivariant_egnn__graph_kernel
.p2align 8
.type gather_scatter__cheap_equivariant_egnn__graph_kernel,@function
gather_scatter__cheap_equivariant_egnn__graph_kernel:
    s_cmp_ge_u32 s2, 256
    s_cbranch_scc1 L_end
    s_load_dwordx16 s[8:23], s[0:1], 0
    s_load_dwordx4 s[24:27], s[0:1], 64
    s_load_dwordx2 s[28:29], s[0:1], 80
    v_cmp_gt_u32 vcc, 12, v0
    s_getpc_b64 s[30:31]
L_pc:
    s_and_b64 exec, exec, vcc
    s_cbranch_execz L_npf
    s_bfe_u32 s6, s2, 0x40003
    s_lshl_b32 s6, s6, 7
    v_lshl_add_u32 v73, v0, 11, s6
    v_min_u32 v73, L_codeend-L_pc-4, v73
    global_load_ubyte v73, v73, s[30:31]
L_npf:
    s_mov_b64 exec, -1
    v_lshrrev_b32 v2, 6, v0
    v_xor_b32 v1, 0x200, v0
    v_readfirstlane_b32 s100, v2
    v_and_b32 v0, 63, v0
    s_and_b32 s5, s2, 7
    s_lshl_b32 s5, s5, 5
    s_lshr_b32 s6, s2, 3
    s_add_u32 s3, s5, s6
    s_xor_b32 s4, s100, 8
    v_mov_b64 v[44:45], 0
    v_mov_b32 v43, 1
    v_mov_b64 v[18:19], 0
    v_mov_b64 v[46:47], 0
    s_cmp_ge_u32 s4, 8
    s_cbranch_scc1 L_e_gemm
    s_cmp_eq_u32 s4, 7
    s_cbranch_scc1 L_e_misc
L_e_bin:
    v_lshlrev_b32 v16, 3, v1
    s_mul_i32 s7, s2, 6256
    ds_write_b64 v16, v[44:45] offset:768
    v_lshl_add_u32 v19, v1, 4, s7
    v_cmp_gt_u32 vcc, 0x187, v1
    s_mov_b32 s6, 1600000
    v_cmp_gt_u32 s[70:71], s6, v19
    v_lshrrev_b32 v47, 1, v19
    s_waitcnt lgkmcnt(0)
    s_and_b64 s[70:71], s[70:71], vcc
    s_mov_b64 exec, s[70:71]
    s_cbranch_execz L_b0
    global_load_dwordx4 v[48:51], v19, s[16:17]
    global_load_dwordx4 v[52:55], v19, s[14:15]
L_b0:
    s_mov_b64 exec, -1
    s_setprio 2
    s_barrier
    s_branch L_setup
L_e_misc:
    v_lshlrev_b32 v19, 2, v0
    v_lshrrev_b32 v12, 3, v0
    v_and_b32 v13, 3, v0
    v_and_b32 v14, 4, v0
    v_lshlrev_b32 v14, 2, v14
    v_mov_b32 v23, 0x3f80
    v_lshlrev_b32 v14, v14, v23
    v_cmp_eq_u32 vcc, v12, v13
    s_nop 1
    v_cndmask_b32 v14, 0, v14, vcc
    ds_write_b32 v19, v14
    s_lshr_b32 s5, s2, 3
    s_lshl_b32 s5, s5, 11
    v_and_b32 v15, 15, v0
    v_lshl_add_u32 v15, v15, 7, s5
    s_waitcnt lgkmcnt(0)
    s_mov_b64 exec, 0xffff
    global_load_dword v74, v15, s[18:19]
    s_mov_b64 exec, -1
    s_barrier
    s_branch L_setup
L_e_gemm:
    s_sub_u32 s30, s4, 8
    s_lshl_b32 s5, s30, 12
    v_lshrrev_b32 v48, 4, v0
    v_and_b32 v49, 15, v0
    s_and_b32 s6, s30, 1
    s_lshl_b32 s7, s6, 5
    s_and_b32 s31, s30, 6
    s_add_u32 s7, s7, s31
    s_lshl_b32 s7, s7, 8
    s_add_u32 s7, s7, s3
    s_lshl_b32 s7, s7, 8
    s_lshl_b32 s6, s6, 3
    v_add_u32 v52, s6, v48
    v_xor_b32 v52, v52, v49
    v_lshlrev_b32 v52, 4, v52
    v_lshl_add_u32 v52, v48, 19, v52
    v_add_u32 v18, s7, v52
    v_xor_b32 v19, 64, v18
    v_add_u32 v19, 0x10000, v19
    s_lshl_b32 s31, s30, 11
    s_mov_b32 s34, 3200000
    s_mov_b32 s35, 0x20000
    v_lshlrev_b32 v50, 2, v48
    v_xor_b32 v50, v50, v49
    v_lshlrev_b32 v50, 4, v50
    v_lshl_add_u32 v50, v48, 8, v50
    v_add_u32 v47, s5, v50
    v_add_u32 v50, 0x8000, v47
    v_lshl_add_u32 v45, v0, 4, s5
    s_waitcnt lgkmcnt(0)
    s_mov_b64 s[32:33], s[8:9]
    s_nop 0
    s_barrier
    global_load_dwordx4 v[104:107], v50, s[18:19] offset:0
    global_load_dwordx4 v[108:111], v50, s[18:19] offset:1024
    global_load_dwordx4 v[112:115], v50, s[18:19] offset:2048
    global_load_dwordx4 v[116:119], v50, s[18:19] offset:3072
    buffer_load_dwordx4 v[96:99], v18, s[32:35], 0 offen
    buffer_load_dwordx4 v[100:103], v19, s[32:35], 0 offen
L_setup:
    s_load_dword s60, s[28:29], 0
    s_mov_b32 s40, s28
    s_mov_b32 s41, s29
    s_mov_b32 s42, 16777216
    s_mov_b32 s43, 0x20000
    s_mov_b32 s36, s10
    s_mov_b32 s37, s11
    s_mov_b32 s38, 75000
    s_mov_b32 s39, 0x20000
    s_add_u32 s48, s28, 6288384
    s_addc_u32 s49, s29, 0
    s_and_b32 s49, s49, 0xffff
    s_or_b32 s49, s49, 16777216
    s_mov_b32 s50, 12544
    s_mov_b32 s51, 0x20000
    s_mov_b32 s52, s24
    s_mov_b32 s53, s25
    s_mov_b32 s54, 3200000
    s_mov_b32 s55, 0x20000
    s_add_u32 s56, s24, 3200000
    s_addc_u32 s57, s25, 0
    s_mov_b32 s58, 75000
    s_mov_b32 s59, 0x20000
    s_and_b32 s5, s4, 7
    s_cmp_eq_u32 s5, 7
    s_cselect_b32 s5, 0x200, 0
    v_xor_b32 v2, s5, v1
    s_and_b32 s62, s100, 1
    s_lshr_b32 s63, s100, 2
    s_lshr_b32 s61, s100, 1
    s_mul_i32 s66, s100, 4096
    s_add_u32 s66, s66, 88064
    s_mov_b32 s73, 2097152
    s_mov_b32 s67, 0
    s_mov_b32 s101, 0
    s_mov_b32 s98, 0
    s_mul_i32 s6, s61, 5632
    s_add_u32 s6, s6, 10368
    v_lshrrev_b32 v56, 5, v0
    v_and_b32 v57, 31, v0
    v_lshrrev_b32 v58, 1, v57
    v_xor_b32 v58, v58, v57
    v_and_b32 v58, 2, v58
    v_mul_u32_u24 v58, 3, v58
    v_xor_b32 v58, v58, v57
    v_lshl_add_u32 v6, v58, 4, s6
    v_bfe_u32 v58, v0, 2, 2
    v_and_b32 v63, 2, v58
    v_add_u32 v58, v58, v63
    v_lshl_add_u32 v58, v56, 1, v58
    v_lshl_add_u32 v9, v58, 4, s6
    v_lshrrev_b32 v63, 3, v0
    v_lshrrev_b32 v58, 1, v63
    v_xor_b32 v58, v58, v63
    v_and_b32 v58, 2, v58
    v_mul_u32_u24 v58, 3, v58
    v_xor_b32 v58, v58, v63
    v_lshl_add_u32 v7, v58, 4, s6
    s_lshl_b32 s5, s61, 2
    v_mov_b32 v21, s5
    s_lshr_b32 s5, s2, 3
    s_lshr_b32 s6, s5, 1
    s_lshl_b32 s7, s4, 4
    s_add_u32 s6, s6, s7
    v_lshl_add_u32 v40, v0, 8, s6
    s_and_b32 s5, s5, 1
    s_lshl_b32 s99, s5, 7
    s_lshl_b32 s5, s62, 7
    v_lshl_add_u32 v41, v57, 1, s5
    v_lshlrev_b32 v41, 1, v41
    v_and_b32 v59, 3, v0
    v_and_b32 v61, 7, v0
    v_lshl_add_u32 v13, v61, 4, s5
    v_lshrrev_b32 v23, 3, v0
    v_lshrrev_b32 v60, 1, v61
    v_lshlrev_b32 v20, 1, v23
    v_lshrrev_b32 v20, v60, v20
    v_xor_b32 v20, v20, v61
    v_bfe_i32 v20, v20, 0, 1
    v_lshlrev_b32 v22, 1, v61
    v_bfe_u32 v62, v0, 1, 1
    v_lshl_add_u32 v62, v62, 3, s66
    v_and_b32 v60, 16, v0
    v_add_u32 v62, v62, v60
    v_and_b32 v60, 1, v0
    v_lshl_add_u32 v62, v60, 5, v62
    v_lshl_add_u32 v62, v56, 9, v62
    v_and_b32 v60, 8, v0
    v_lshl_add_u32 v62, v60, 4, v62
    v_bfi_b32 v60, v0, 0, 4
    v_lshl_add_u32 v4, v60, 20, v62
    s_lshl_b32 s5, s61, 9
    s_lshl_b32 s7, s62, 13
    s_add_u32 s5, s5, s7
    s_add_u32 s5, s5, 71680
    v_lshl_add_u32 v3, v57, 4, s5
    v_bfe_u32 v58, v0, 2, 3
    v_lshrrev_b32 v59, 5, v0
    s_lshl_b32 s6, s62, 8
    v_lshl_add_u32 v5, v59, 4, s6
    v_lshl_add_u32 v59, v59, 5, s66
    s_movk_i32 s7, 144
    v_mad_u32_u24 v10, v58, s7, v59
    v_lshl_add_u32 v58, v58, 3, s61
    v_lshl_add_u32 v58, v58, 8, s3
    v_and_b32 v59, 3, v0
    v_lshl_add_u32 v59, v59, 1, -2
    v_mad_u32_u24 v11, v58, 6, v59
    v_and_b32 v42, 15, v0
    s_lshl_b32 s5, s4, 6
    s_add_u32 s5, s5, 10616832
    v_lshl_add_u32 v42, v42, 2, s5
    s_cmp_ge_u32 s4, 8
    s_cbranch_scc1 L_p_gemm
    s_cmp_eq_u32 s4, 7
    s_cbranch_scc1 L_p_misc
    v_lshlrev_b32 v14, 4, v0
    v_lshlrev_b32 v15, 2, v1
    v_lshlrev_b32 v18, 4, v1
    s_lshl_b32 s31, s2, 12
    s_add_u32 s31, s31, 1048576
    s_mov_b32 s5, 0x0c050100
    s_mov_b64 exec, s[70:71]
    s_waitcnt vmcnt(1)
    v_lshlrev_b32_sdwa v58, 2, v48 dst_sel:DWORD dst_unused:UNUSED_PAD src0_sel:DWORD src1_sel:BYTE_0
    v_lshlrev_b32_sdwa v62, 2, v48 dst_sel:DWORD dst_unused:UNUSED_PAD src0_sel:DWORD src1_sel:BYTE_1
    ds_add_rtn_u32 v82, v58, v43 offset:768
    v_lshlrev_b32 v74, v62, v43
    v_lshlrev_b32_sdwa v59, 2, v49 dst_sel:DWORD dst_unused:UNUSED_PAD src0_sel:DWORD src1_sel:BYTE_0
    v_lshlrev_b32_sdwa v63, 2, v49 dst_sel:DWORD dst_unused:UNUSED_PAD src0_sel:DWORD src1_sel:BYTE_1
    ds_add_rtn_u32 v83, v59, v43 offset:768
    v_lshlrev_b32 v75, v63, v43
    v_lshlrev_b32_sdwa v60, 2, v50 dst_sel:DWORD dst_unused:UNUSED_PAD src0_sel:DWORD src1_sel:BYTE_0
    v_lshlrev_b32_sdwa v64, 2, v50 dst_sel:DWORD dst_unused:UNUSED_PAD src0_sel:DWORD src1_sel:BYTE_1
    ds_add_rtn_u32 v84, v60, v43 offset:768
    v_lshlrev_b32 v76, v64, v43
    v_lshlrev_b32_sdwa v61, 2, v51 dst_sel:DWORD dst_unused:UNUSED_PAD src0_sel:DWORD src1_sel:BYTE_0
    v_lshlrev_b32_sdwa v65, 2, v51 dst_sel:DWORD dst_unused:UNUSED_PAD src0_sel:DWORD src1_sel:BYTE_1
    ds_add_rtn_u32 v85, v61, v43 offset:768
    v_lshlrev_b32 v77, v65, v43
    s_waitcnt vmcnt(0)
    s_movk_i32 s6, 2560
    v_cmp_gt_u32 s[8:9], s6, v52
    v_cmp_gt_u32 s[10:11], s6, v53
    v_cmp_gt_u32 vcc, s6, v54
    v_cmp_gt_u32 s[68:69], s6, v55
    v_cndmask_b32_e64 v78, 4, 0, s[8:9]
    v_lshl_add_u32 v90, v58, 1, v78
    ds_add_rtn_u32 v86, v90, v74 offset:1792
    v_cndmask_b32_e64 v79, 4, 0, s[10:11]
    v_lshl_add_u32 v91, v59, 1, v79
    ds_add_rtn_u32 v87, v91, v75 offset:1792
    v_cndmask_b32_e64 v80, 4, 0, vcc
    v_lshl_add_u32 v92, v60, 1, v80
    ds_add_rtn_u32 v88, v92, v76 offset:1792
    v_cndmask_b32_e64 v81, 4, 0, s[68:69]
    v_lshl_add_u32 v93, v61, 1, v81
    ds_add_rtn_u32 v89, v93, v77 offset:1792
    s_mov_b64 exec, 1
    ds_add_u32 v44, v43 offset:196
    s_mov_b64 exec, -1
    s_mov_b64 exec, s[70:71]
    s_cbranch_execz L_nsl
    global_load_dwordx2 v[46:47], v47, s[12:13]
L_nsl:
    s_mov_b64 exec, -1
    v_perm_b32 v66, v48, v52, s5
    v_cndmask_b32_e64 v74, 0, 15, s[8:9]
    v_lshl_or_b32 v66, v78, 13, v66
    v_perm_b32 v68, v49, v53, s5
    v_cndmask_b32_e64 v75, 0, 15, s[10:11]
    v_lshl_or_b32 v68, v79, 13, v68
    v_perm_b32 v70, v50, v54, s5
    v_cndmask_b32_e64 v76, 0, 15, vcc
    v_lshl_or_b32 v70, v80, 13, v70
    v_perm_b32 v72, v51, v55, s5
    v_cndmask_b32_e64 v77, 0, 15, s[68:69]
    v_lshl_or_b32 v72, v81, 13, v72
    s_mov_b32 s72, 4194304
    s_branch L_s1e
L_s1:
    s_sleep 1
    s_sub_u32 s72, s72, 1
    s_cbranch_scc1 L_s1d
L_s1e:
    ds_read_b32 v90, v44 offset:196
    s_waitcnt lgkmcnt(0)
    v_readfirstlane_b32 s30, v90
    s_cmp_lt_u32 s30, 7
    s_cbranch_scc1 L_s1
L_s1d:
    ds_read_b128 v[92:95], v14 offset:768
    ds_read_b32 v99, v15 offset:768
    ds_read_b64 v[96:97], v16 offset:1792
    s_add_u32 s60, s60, 0x55400010
    s_and_b32 s75, s60, 0xffc0fff0
    s_and_b32 s6, s60, 0xffc00000
    s_and_b32 s7, s60, 0xfff0
    s_andn2_b32 s5, 0xf800f800, s60
    v_mov_b32 v103, s60
    v_bfe_u32 v86, v86, v62, 4
    v_xad_u32 v86, v86, v74, s7
    v_bfe_u32 v87, v87, v63, 4
    v_xad_u32 v87, v87, v75, s7
    v_bfe_u32 v88, v88, v64, 4
    v_xad_u32 v88, v88, v76, s7
    v_bfe_u32 v89, v89, v65, 4
    v_xad_u32 v89, v89, v77, s7
    s_waitcnt lgkmcnt(2)
    v_add_u32 v104, v92, v93
    v_add3_u32 v104, v104, v94, v95
    v_mov_b32 v105, v104
    s_nop 1
    v_add_u32_dpp v105, v105, v105 row_shr:1 row_mask:0xf bank_mask:0xf bound_ctrl:1
    s_nop 1
    v_add_u32_dpp v105, v105, v105 row_shr:2 row_mask:0xf bank_mask:0xf bound_ctrl:1
    s_nop 1
    v_add_u32_dpp v105, v105, v105 row_shr:4 row_mask:0xf bank_mask:0xf bound_ctrl:1
    s_nop 1
    v_add_u32_dpp v105, v105, v105 row_shr:8 row_mask:0xf bank_mask:0xf bound_ctrl:1
    s_nop 1
    v_add_u32_dpp v105, v105, v105 row_bcast:15 row_mask:0xa bank_mask:0xf
    s_nop 1
    v_add_u32_dpp v105, v105, v105 row_bcast:31 row_mask:0xc bank_mask:0xf
    v_sub_u32 v108, v105, v104
    v_add_u32 v109, v108, v92
    v_add_u32 v110, v109, v93
    v_add_u32 v111, v110, v94
    ds_write_b128 v14, v[108:111] offset:3840
    ds_read_b32 v106, v15 offset:3840
    s_mov_b64 exec, s[70:71]
    ds_read_b32 v92, v58 offset:3840
    ds_read_b32 v93, v59 offset:3840
    ds_read_b32 v94, v60 offset:3840
    ds_read_b32 v95, v61 offset:3840
    s_mov_b64 exec, -1
    s_cmp_ge_u32 s4, 4
    s_cbranch_scc1 L_b2
    s_waitcnt lgkmcnt(6)
    v_lshl_or_b32 v100, v99, 16, s5
    v_mov_b32 v101, v96
    v_mov_b32 v102, v97
    s_waitcnt lgkmcnt(4)
    v_or_b32 v100, v100, v106
    buffer_store_dwordx4 v[100:103], v18, s[40:43], s31 offen sc1
    s_waitcnt vmcnt(1)
    s_branch L_b3
L_b2:
    s_waitcnt vmcnt(0)
L_b3:
    s_mov_b64 exec, s[70:71]
    s_mov_b32 s31, 0xffff0000
    v_lshl_or_b32 v67, v46, 16, v86
    v_or_b32 v66, s6, v66
    s_waitcnt lgkmcnt(3)
    v_add_lshl_u32 v92, v92, v82, 3
    ds_write_b64 v92, v[66:67] offset:41728
    v_and_or_b32 v69, v46, s31, v87
    v_or_b32 v68, s6, v68
    s_waitcnt lgkmcnt(3)
    v_add_lshl_u32 v93, v93, v83, 3
    ds_write_b64 v93, v[68:69] offset:41728
    v_lshl_or_b32 v71, v47, 16, v88
    v_or_b32 v70, s6, v70
    s_waitcnt lgkmcnt(3)
    v_add_lshl_u32 v94, v94, v84, 3
    ds_write_b64 v94, v[70:71] offset:41728
    v_and_or_b32 v73, v47, s31, v89
    v_or_b32 v72, s6, v72
    s_waitcnt lgkmcnt(3)
    v_add_lshl_u32 v95, v95, v85, 3
    ds_write_b64 v95, v[72:73] offset:41728
    s_mov_b64 exec, 1
    ds_add_u32 v44, v43 offset:196
    s_mov_b64 exec, -1
    v_add_u32 v12, 0xfffff000, v18
    s_mul_i32 s5, s2, 12544
    s_add_u32 s5, s5, 2097152
    s_mov_b32 s72, 4194304
    s_branch L_s2e
L_s2:
    s_sleep 1
    s_sub_u32 s72, s72, 1
    s_cbranch_scc1 L_s2d
L_s2e:
    ds_read_b32 v90, v44 offset:196
    s_waitcnt lgkmcnt(0)
    v_readfirstlane_b32 s30, v90
    s_cmp_lt_u32 s30, 14
    s_cbranch_scc1 L_s2
L_s2d:
    s_cmp_lt_u32 s4, 4
    s_cbranch_scc1 L_prep
    ds_read_b128 v[48:51], v12 offset:41728
    ds_read_b128 v[52:55], v12 offset:44800
    ds_read_b128 v[56:59], v12 offset:47872
    ds_read_b128 v[60:63], v12 offset:50944
    ds_read_b128 v[64:67], v12 offset:54016
    s_waitcnt lgkmcnt(4)
    buffer_store_dwordx4 v[48:51], v12, s[40:43], s5 offen sc1
    s_add_u32 s5, s5, 3072
    s_waitcnt lgkmcnt(3)
    buffer_store_dwordx4 v[52:55], v12, s[40:43], s5 offen sc1
    s_add_u32 s5, s5, 3072
    s_waitcnt lgkmcnt(2)
    buffer_store_dwordx4 v[56:59], v12, s[40:43], s5 offen sc1
    s_add_u32 s5, s5, 3072
    s_waitcnt lgkmcnt(1)
    buffer_store_dwordx4 v[60:63], v12, s[40:43], s5 offen sc1
    s_add_u32 s5, s5, 3072
    s_waitcnt lgkmcnt(0)
    s_cmp_lg_u32 s4, 4
    s_cbranch_scc1 L_p47
    s_mov_b64 exec, 0xffff
    buffer_store_dwordx4 v[64:67], v12, s[40:43], s5 offen sc1
    s_mov_b64 exec, -1
    s_branch L_p47
L_p_misc:
    s_lshr_b32 s5, s2, 2
    s_and_b32 s6, s5, 7
    s_and_b32 s7, s2, 3
    v_and_b32 v12, 3, v0
    v_lshlrev_b32 v12, 1, v12
    s_cmp_ge_u32 s6, 4
    s_cbranch_scc1 L_m1
    s_lshl_b32 s7, s7, 3
    v_add_u32 v17, s7, v12
    s_mov_b32 s31, 0xbfb8aa3b
    s_branch L_m2
L_m1:
    s_and_b32 s30, s7, 1
    s_lshl_b32 s30, s30, 4
    s_lshr_b32 s7, s7, 1
    s_lshl_b32 s7, s7, 2
    s_add_u32 s7, s7, s30
    v_and_b32 v17, 4, v12
    v_add3_u32 v17, v17, v12, s7
    s_mov_b32 s31, 1.0
L_m2:
    s_lshl_b32 s6, s6, 13
    s_lshr_b32 s7, s5, 4
    s_lshl_b32 s7, s7, 6
    s_add_u32 s6, s6, s7
    s_bfe_u32 s7, s5, 0x10003
    s_lshl_b32 s7, s7, 1
    s_add_u32 s6, s6, s7
    v_and_b32 v16, 60, v0
    v_lshl_add_u32 v16, v17, 8, v16
    v_add_u32 v16, s6, v16
    v_lshl_add_u32 v12, v0, 8, s3
    v_mul_u32_u24 v12, 6, v12
    s_lshr_b32 s5, s2, 3
    s_mul_i32 s5, s5, 2432
    v_min_u32 v15, 18, v0
    v_lshl_add_u32 v15, v15, 7, s5
    v_lshlrev_b32 v19, 2, v0
    v_lshlrev_b32 v18, 3, v0
    v_add_u32 v17, 0x10000, v19
    buffer_load_dword v24, v15, s[36:39], 0 offen
    s_mov_b32 s72, 4194304
    s_branch L_mwe
L_mw:
    s_sleep 1
    s_sub_u32 s72, s72, 1
    s_cbranch_scc1 L_mwd
L_mwe:
    ds_read_b32 v47, v44 offset:196
    s_waitcnt lgkmcnt(0)
    v_readfirstlane_b32 s30, v47
    s_cmp_lt_u32 s30, 7
    s_cbranch_scc1 L_mw
L_mwd:
    global_load_ushort v25, v16, s[22:23]
    global_load_ushort v26, v16, s[22:23] offset:256
    global_load_dword v27, v19, s[20:21]
    global_load_dword v28, v17, s[18:19]
    global_load_dword v29, v17, s[18:19] offset:256
    buffer_load_ushort v30, v12, s[36:39], 0 offen
    buffer_load_ushort v31, v12, s[36:39], 0 offen offset:2
    buffer_load_ushort v32, v12, s[36:39], 0 offen offset:4
    s_waitcnt vmcnt(0) lgkmcnt(0)
    s_add_u32 s60, s60, 0x55400010
    s_and_b32 s75, s60, 0xffc0fff0
    v_lshlrev_b32 v25, 16, v25
    v_lshlrev_b32 v26, 16, v26
    v_mul_f32 v25, s31, v25
    v_mul_f32 v26, s31, v26
    v_cvt_pk_bf16_f32 v25, v25, v26
    s_lshl_b32 s5, s2, 8
    s_add_u32 s5, s5, 10485760
    buffer_store_dword v25, v19, s[40:43], s5 offen sc1
    v_lshl_or_b32 v30, v31, 16, v30
    v_lshlrev_b32 v31, 16, v32
    v_lshlrev_b32 v36, 16, v27
    v_and_b32 v37, 0xffff0000, v27
    ds_write_b64 v18, v[36:37] offset:256
    s_mov_b32 s5, 0x05040100
    s_mov_b32 s6, 0x07060302
    v_perm_b32 v34, v29, v28, s5
    v_perm_b32 v35, v29, v28, s6
    ds_write_b64 v18, v[34:35] offset:54784
    s_mov_b32 exec_hi, 0xffffff
    ds_write_b64 v18, v[30:31] offset:54272
    s_mov_b32 exec_hi, -1
    s_mov_b32 s72, 4194304
    s_branch L_pwe
L_pw:
    s_sleep 1
    s_sub_u32 s72, s72, 1
    s_cbranch_scc1 L_pwd
L_pwe:
    ds_read_b32 v47, v44 offset:196
    s_waitcnt lgkmcnt(0)
    v_readfirstlane_b32 s30, v47
    s_cmp_lt_u32 s30, 14
    s_cbranch_scc1 L_pw
L_pwd:
L_p47:
    s_setprio 0
    v_bfe_u32 v56, v0, 4, 1
    v_and_b32 v57, 3, v0
    v_lshl_add_u32 v56, v56, 2, v57
    v_lshlrev_b32 v8, 20, v56
    v_mov_b64 v[36:37], 0
    v_mov_b64 v[38:39], 0
    s_movk_i32 s7, 144
    s_cmp_lg_u32 s63, 0
    s_cbranch_scc1 L_ss1
    v_lshrrev_b32 v56, 4, v0
    v_bfe_u32 v57, v0, 3, 1
    v_and_b32 v58, 7, v0
    v_lshlrev_b32 v32, 4, v56
    v_mad_u32_u24 v32, v58, s7, v32
    v_lshl_add_u32 v32, v57, 13, v32
    v_and_b32 v59, 4, v58
    v_add_u32 v59, v59, v58
    v_lshl_add_u32 v59, v57, 2, v59
    v_xor_b32 v33, v56, v59
    v_lshlrev_b32 v33, 4, v33
    v_lshl_add_u32 v33, v59, 8, v33
    v_add_u32 v33, 55296, v33
    v_and_b32 v57, 1, v56
    v_lshrrev_b32 v56, 1, v56
    v_lshlrev_b32 v58, 2, v56
    v_lshl_add_u32 v58, v57, 3, v58
    v_bfe_u32 v59, v0, 2, 2
    s_lshl_b32 s5, s100, 2
    v_add_u32 v59, s5, v59
    v_xor_b32 v59, v59, v58
    v_lshlrev_b32 v59, 4, v59
    v_lshl_add_u32 v59, v58, 8, v59
    v_and_b32 v58, 3, v0
    v_lshl_add_u32 v34, v58, 2, v59
    v_lshl_add_u32 v57, v57, 5, v56
    v_and_b32 v58, 15, v0
    s_lshl_b32 s6, s3, 8
    s_lshl_b32 s5, s100, 6
    s_add_u32 s6, s6, s5
    v_lshl_add_u32 v58, v58, 2, s6
    v_lshl_add_u32 v35, v57, 16, v58
L_ss1:
    v_mov_b32 v25, 0
    v_mov_b64 v[26:27], 0
    v_mov_b32 v29, 0
    v_mov_b64 v[30:31], 0
    v_mov_b32 v19, v13
    v_add_u32 v17, 0x400, v13
    v_add_u32 v15, 0x800, v13
    v_add_u32 v13, 0xc00, v13
    v_mov_b32 v45, 0x3fff
    v_mov_b64 v[46:47], 0
    v_lshlrev_b32 v14, 2, v2
    s_waitcnt vmcnt(0)
    v_lshlrev_b32 v56, 10, v0
    v_mov_b32 v57, s60
    s_mov_b64 exec, 1
    ds_add_rtn_u32 v58, v44, v43 offset:156
    s_lshl_b32 s5, s2, 2
    s_add_u32 s5, s5, 10616832
    s_waitcnt lgkmcnt(0)
    v_readfirstlane_b32 s6, v58
    s_cmp_lg_u32 s6, 11
    s_cbranch_scc1 L_ds0
    s_mov_b64 exec, 0xff
    buffer_store_dword v57, v56, s[40:43], s5 offen sc1
L_ds0:
    s_mov_b64 exec, -1
    s_mov_b32 s72, 4194304
    s_branch L_pw6e
L_pw6:
    s_sleep 1
    s_sub_u32 s72, s72, 1
    s_cbranch_scc1 L_pw6d
L_pw6e:
    ds_read_b32 v63, v44 offset:196
    s_waitcnt lgkmcnt(0)
    v_readfirstlane_b32 s30, v63
    s_cmp_lt_u32 s30, 18
    s_cbranch_scc1 L_pw6
L_pw6d:
    s_sub_u32 s7, s4, 4
    s_mul_i32 s7, s7, 11
    s_lshl_b32 s7, s7, 10
    v_lshl_add_u32 v12, v0, 4, s7
    v_add_u32 v16, 88064, v12
    buffer_load_dwordx4 v[84:87], v12, s[36:39], 0 offen offset:0
    buffer_load_dwordx4 v[88:91], v12, s[36:39], 0 offen offset:1024
    buffer_load_dwordx4 v[92:95], v12, s[36:39], 0 offen offset:2048
    buffer_load_dwordx4 v[96:99], v12, s[36:39], 0 offen offset:3072
    v_add_u32 v12, 0x1000, v12
    buffer_load_dwordx4 v[100:103], v12, s[36:39], 0 offen offset:0
    buffer_load_dwordx4 v[104:107], v12, s[36:39], 0 offen offset:1024
    buffer_load_dwordx4 v[108:111], v12, s[36:39], 0 offen offset:2048
    buffer_load_dwordx4 v[112:115], v12, s[36:39], 0 offen offset:3072
    v_add_u32 v12, 0x1000, v12
    buffer_load_dwordx4 v[116:119], v12, s[36:39], 0 offen offset:0
    buffer_load_dwordx4 v[120:123], v12, s[36:39], 0 offen offset:1024
    buffer_load_dwordx4 v[124:127], v12, s[36:39], 0 offen offset:2048
    s_mov_b32 s72, 4194304
    s_branch L_sl0e
L_sl0:
    s_sleep 1
    s_sub_u32 s72, s72, 1
    s_cbranch_scc1 L_sl0d
L_sl0e:
    ds_read_b32 v48, v44 offset:204
    s_waitcnt lgkmcnt(0)
    v_readfirstlane_b32 s30, v48
    s_cmp_lt_u32 s30, 4
    s_cbranch_scc1 L_sl0
L_sl0d:
    ds_read_b32 v48, v14 offset:768
    ds_read_b64 v[50:51], v44 offset:144
    v_bfrev_b32 v53, 2
    s_waitcnt lgkmcnt(0)
    v_cmp_lt_u32_sdwa s[70:71], v2, v50 src0_sel:DWORD src1_sel:WORD_0
    v_and_b32 v49, 0x3ffff, v48
    v_lshlrev_b32 v49, 4, v49
    v_cndmask_b32 v49, v53, v49, s[70:71]
    buffer_load_dwordx4 v[64:67], v49, s[40:43], s73 offen sc1
    s_waitcnt vmcnt(11)
    ds_write_b128 v16, v[84:87] offset:0
    s_waitcnt vmcnt(10)
    ds_write_b128 v16, v[88:91] offset:1024
    s_waitcnt vmcnt(9)
    ds_write_b128 v16, v[92:95] offset:2048
    s_waitcnt vmcnt(8)
    ds_write_b128 v16, v[96:99] offset:3072
    s_waitcnt vmcnt(7)
    ds_write_b128 v16, v[100:103] offset:4096
    s_waitcnt vmcnt(6)
    ds_write_b128 v16, v[104:107] offset:5120
    s_waitcnt vmcnt(5)
    ds_write_b128 v16, v[108:111] offset:6144
    s_waitcnt vmcnt(4)
    ds_write_b128 v16, v[112:115] offset:7168
    s_waitcnt vmcnt(3)
    ds_write_b128 v16, v[116:119] offset:8192
    s_waitcnt vmcnt(2)
    ds_write_b128 v16, v[120:123] offset:9216
    s_waitcnt vmcnt(1)
    ds_write_b128 v16, v[124:127] offset:10240
    v_mov_b64 v[96:97], 0
    v_mov_b64 v[98:99], 0
    v_mov_b64 v[100:101], 0
    v_mov_b64 v[102:103], 0
    v_mov_b64 v[104:105], 0
    v_mov_b64 v[106:107], 0
    v_mov_b64 v[108:109], 0
    v_mov_b64 v[110:111], 0
    v_mov_b64 v[112:113], 0
    v_mov_b64 v[114:115], 0
    v_mov_b64 v[116:117], 0
    v_mov_b64 v[118:119], 0
    v_mov_b64 v[120:121], 0
    v_mov_b64 v[122:123], 0
    v_mov_b64 v[124:125], 0
    v_mov_b64 v[126:127], 0
    s_cmp_lg_u32 s4, 7
    s_cbranch_scc1 L_p1
    s_setprio 2
    s_branch L_p1
L_p_gemm:
    s_setprio 1
    s_add_u32 s31, s31, 71680
    v_lshl_add_u32 v17, v0, 4, s31
    s_and_b32 s5, s4, 1
    s_bfe_u32 s6, s4, 0x20001
    v_lshrrev_b32 v52, 5, v0
    v_bfe_u32 v53, v0, 2, 2
    v_xor_b32 v54, s6, v53
    v_lshlrev_b32 v54, 6, v54
    v_lshl_add_u32 v54, v53, 8, v54
    v_lshl_add_u32 v54, v52, 11, v54
    v_bfe_u32 v55, v0, 4, 1
    v_lshl_add_u32 v54, v55, 5, v54
    v_and_b32 v55, 3, v0
    v_lshl_add_u32 v12, v55, 3, v54
    v_and_b32 v53, 31, v0
    s_lshl_b32 s7, s5, 13
    v_lshl_add_u32 v54, v53, 8, s7
    v_xor_b32 v55, v52, v49
    v_lshl_add_u32 v14, v55, 4, v54
    s_lshl_b32 s7, s6, 2
    v_lshl_add_u32 v55, v52, 1, s7
    v_xor_b32 v55, v55, v49
    v_lshl_add_u32 v15, v55, 4, v54
    v_add_u32 v15, 71680, v15
    v_xor_b32 v16, 16, v15
    s_add_u32 s44, s28, 6291456
    s_addc_u32 s45, s29, 0
    s_mov_b32 s46, 3211264
    s_mov_b32 s47, 0x20000
    v_xor_b32 v64, 0x0, v14
    v_xor_b32 v68, 0x20, v14
    v_xor_b32 v72, 0x40, v14
    v_xor_b32 v76, 0x60, v14
    v_xor_b32 v80, 0x80, v14
    v_xor_b32 v84, 0xa0, v14
    v_xor_b32 v88, 0xc0, v14
    v_xor_b32 v92, 0xe0, v14
    v_add_u32 v46, 0xffffc000, v17
    s_waitcnt vmcnt(5)
    ds_write_b128 v45, v[104:107] offset:8960
    s_waitcnt vmcnt(4)
    ds_write_b128 v45, v[108:111] offset:9984
    s_waitcnt vmcnt(3)
    ds_write_b128 v45, v[112:115] offset:11008
    s_waitcnt vmcnt(2)
    ds_write_b128 v45, v[116:119] offset:12032
    s_waitcnt vmcnt(1)
    ds_write_b128 v46, v[96:99]
    s_waitcnt vmcnt(0)
    ds_write_b128 v46, v[100:103] offset:1024
    s_mov_b64 exec, 1
    ds_add_u32 v44, v43 offset:152
    s_mov_b64 exec, -1
    global_load_dwordx4 v[24:27], v47, s[18:19] offset:0
    global_load_dwordx4 v[28:31], v47, s[18:19] offset:1024
    global_load_dwordx4 v[32:35], v47, s[18:19] offset:2048
    global_load_dwordx4 v[36:39], v47, s[18:19] offset:3072
    s_mov_b32 s72, 4194304
    s_branch L_g1e
L_g1:
    s_sleep 1
    s_sub_u32 s72, s72, 1
    s_cbranch_scc1 L_g1d
L_g1e:
    ds_read_b32 v46, v44 offset:152
    s_waitcnt lgkmcnt(0)
    v_readfirstlane_b32 s30, v46
    s_cmp_lt_u32 s30, 8
    s_cbranch_scc1 L_g1
L_g1d:
    ds_read_b128 v[64:67], v64 offset:55296
    ds_read_b64_tr_b16 v[96:97], v12 offset:8960
    ds_read_b64_tr_b16 v[98:99], v12 offset:9984
    ds_read_b128 v[68:71], v68 offset:55296
    ds_read_b64_tr_b16 v[100:101], v12 offset:13056
    ds_read_b64_tr_b16 v[102:103], v12 offset:14080
    ds_read_b128 v[72:75], v72 offset:55296
    ds_read_b64_tr_b16 v[104:105], v12 offset:17152
    ds_read_b64_tr_b16 v[106:107], v12 offset:18176
    ds_read_b128 v[76:79], v76 offset:55296
    ds_read_b64_tr_b16 v[108:109], v12 offset:21248
    ds_read_b64_tr_b16 v[110:111], v12 offset:22272
    ds_read_b128 v[80:83], v80 offset:55296
    ds_read_b64_tr_b16 v[112:113], v12 offset:25344
    ds_read_b64_tr_b16 v[114:115], v12 offset:26368
    s_waitcnt lgkmcnt(12)
    v_mfma_f32_32x32x16_bf16 v[48:63], v[96:99], v[64:67], 0
    ds_read_b128 v[84:87], v84 offset:55296
    ds_read_b64_tr_b16 v[116:117], v12 offset:29440
    ds_read_b64_tr_b16 v[118:119], v12 offset:30464
    s_waitcnt lgkmcnt(12)
    v_mfma_f32_32x32x16_bf16 v[48:63], v[100:103], v[68:71], v[48:63]
    ds_read_b128 v[88:91], v88 offset:55296
    ds_read_b64_tr_b16 v[120:121], v12 offset:33536
    ds_read_b64_tr_b16 v[122:123], v12 offset:34560
    s_waitcnt lgkmcnt(12)
    v_mfma_f32_32x32x16_bf16 v[48:63], v[104:107], v[72:75], v[48:63]
    ds_read_b128 v[92:95], v92 offset:55296
    ds_read_b64_tr_b16 v[124:125], v12 offset:37632
    ds_read_b64_tr_b16 v[126:127], v12 offset:38656
    s_waitcnt lgkmcnt(12)
    v_mfma_f32_32x32x16_bf16 v[48:63], v[108:111], v[76:79], v[48:63]
    s_waitcnt lgkmcnt(9)
    v_mfma_f32_32x32x16_bf16 v[48:63], v[112:115], v[80:83], v[48:63]
    s_waitcnt lgkmcnt(6)
    v_mfma_f32_32x32x16_bf16 v[48:63], v[116:119], v[84:87], v[48:63]
    s_waitcnt lgkmcnt(3)
    v_mfma_f32_32x32x16_bf16 v[48:63], v[120:123], v[88:91], v[48:63]
    s_waitcnt lgkmcnt(0)
    v_mfma_f32_32x32x16_bf16 v[48:63], v[124:127], v[92:95], v[48:63]
    s_add_u32 s60, s60, 0x55400010
    s_and_b32 s75, s60, 0xffc0fff0
    s_nop 7
    s_nop 3
    v_mul_f32 v48, 0xbfb8aa3b, v48
    v_mul_f32 v49, 0xbfb8aa3b, v49
    v_mul_f32 v50, 0xbfb8aa3b, v50
    v_mul_f32 v51, 0xbfb8aa3b, v51
    v_mul_f32 v52, 0xbfb8aa3b, v52
    v_mul_f32 v53, 0xbfb8aa3b, v53
    v_mul_f32 v54, 0xbfb8aa3b, v54
    v_mul_f32 v55, 0xbfb8aa3b, v55
    v_mul_f32 v56, 0xbfb8aa3b, v56
    v_mul_f32 v57, 0xbfb8aa3b, v57
    v_mul_f32 v58, 0xbfb8aa3b, v58
    v_mul_f32 v59, 0xbfb8aa3b, v59
    v_mul_f32 v60, 0xbfb8aa3b, v60
    v_mul_f32 v61, 0xbfb8aa3b, v61
    v_mul_f32 v62, 0xbfb8aa3b, v62
    v_mul_f32 v63, 0xbfb8aa3b, v63
    v_cvt_pk_bf16_f32 v48, v48, v49
    v_cvt_pk_bf16_f32 v49, v50, v51
    v_cvt_pk_bf16_f32 v50, v52, v53
    v_cvt_pk_bf16_f32 v51, v54, v55
    v_cvt_pk_bf16_f32 v52, v56, v57
    v_cvt_pk_bf16_f32 v53, v58, v59
    v_cvt_pk_bf16_f32 v54, v60, v61
    v_cvt_pk_bf16_f32 v55, v62, v63
    ds_write_b128 v15, v[48:51]
    ds_write_b128 v16, v[52:55]
    s_mov_b64 exec, 1
    ds_add_u32 v44, v43 offset:152
    s_mov_b64 exec, -1
    s_mov_b32 s72, 4194304
    s_branch L_g2e
L_g2:
    s_sleep 1
    s_sub_u32 s72, s72, 1
    s_cbranch_scc1 L_g2d
L_g2e:
    ds_read_b32 v46, v44 offset:152
    s_waitcnt lgkmcnt(0)
    v_readfirstlane_b32 s30, v46
    s_cmp_lt_u32 s30, 16
    s_cbranch_scc1 L_g2
L_g2d:
    ds_read_b128 v[56:59], v17
    ds_read_b128 v[60:63], v17 offset:1024
    s_waitcnt lgkmcnt(1)
    buffer_store_dwordx4 v[56:59], v18, s[44:47], 0 offen sc1
    s_waitcnt lgkmcnt(0)
    buffer_store_dwordx4 v[60:63], v19, s[44:47], 0 offen sc1
    s_setprio 0
    s_waitcnt vmcnt(2)
    ds_write_b128 v45, v[24:27] offset:8960
    ds_write_b128 v45, v[28:31] offset:9984
    ds_write_b128 v45, v[32:35] offset:11008
    ds_write_b128 v45, v[36:39] offset:12032
    s_mov_b64 exec, 1
    ds_add_u32 v44, v43 offset:152
    s_mov_b64 exec, -1
    s_mov_b32 s72, 4194304
    s_branch L_g3e
L_g3:
    s_sleep 1
    s_sub_u32 s72, s72, 1
    s_cbranch_scc1 L_g3d
L_g3e:
    ds_read_b32 v46, v44 offset:152
    s_waitcnt lgkmcnt(0)
    v_readfirstlane_b32 s30, v46
    s_cmp_lt_u32 s30, 24
    s_cbranch_scc1 L_g3
L_g3d:
    ds_read_b64_tr_b16 v[96:97], v12 offset:8960
    ds_read_b64_tr_b16 v[98:99], v12 offset:9984
    ds_read_b64_tr_b16 v[100:101], v12 offset:13056
    ds_read_b64_tr_b16 v[102:103], v12 offset:14080
    ds_read_b64_tr_b16 v[104:105], v12 offset:17152
    ds_read_b64_tr_b16 v[106:107], v12 offset:18176
    ds_read_b64_tr_b16 v[108:109], v12 offset:21248
    ds_read_b64_tr_b16 v[110:111], v12 offset:22272
    ds_read_b64_tr_b16 v[112:113], v12 offset:25344
    ds_read_b64_tr_b16 v[114:115], v12 offset:26368
    ds_read_b64_tr_b16 v[116:117], v12 offset:29440
    ds_read_b64_tr_b16 v[118:119], v12 offset:30464
    ds_read_b64_tr_b16 v[120:121], v12 offset:33536
    ds_read_b64_tr_b16 v[122:123], v12 offset:34560
    s_waitcnt lgkmcnt(10)
    ds_read_b64_tr_b16 v[124:125], v12 offset:37632
    ds_read_b64_tr_b16 v[126:127], v12 offset:38656
    s_waitcnt lgkmcnt(12)
    v_mfma_f32_32x32x16_bf16 v[48:63], v[64:67], v[96:99], 0
    s_waitcnt lgkmcnt(12)
    v_mfma_f32_32x32x16_bf16 v[48:63], v[68:71], v[100:103], v[48:63]
    s_waitcnt lgkmcnt(10)
    v_mfma_f32_32x32x16_bf16 v[48:63], v[72:75], v[104:107], v[48:63]
    s_waitcnt lgkmcnt(8)
    v_mfma_f32_32x32x16_bf16 v[48:63], v[76:79], v[108:111], v[48:63]
    s_waitcnt lgkmcnt(6)
    v_mfma_f32_32x32x16_bf16 v[48:63], v[80:83], v[112:115], v[48:63]
    s_waitcnt lgkmcnt(4)
    v_mfma_f32_32x32x16_bf16 v[48:63], v[84:87], v[116:119], v[48:63]
    s_waitcnt lgkmcnt(2)
    v_mfma_f32_32x32x16_bf16 v[48:63], v[88:91], v[120:123], v[48:63]
    s_waitcnt lgkmcnt(0)
    v_mfma_f32_32x32x16_bf16 v[48:63], v[92:95], v[124:127], v[48:63]
    s_waitcnt vmcnt(0)
    v_lshlrev_b32 v64, 10, v0
    v_mov_b32 v65, s60
    s_mov_b64 exec, 1
    ds_add_rtn_u32 v66, v44, v43 offset:156
    s_lshl_b32 s5, s2, 2
    s_add_u32 s5, s5, 10616832
    s_waitcnt lgkmcnt(0)
    v_readfirstlane_b32 s6, v66
    s_cmp_lg_u32 s6, 11
    s_cbranch_scc1 L_ds1
    s_mov_b64 exec, 0xff
    buffer_store_dword v65, v64, s[40:43], s5 offen sc1
L_ds1:
    s_mov_b64 exec, -1
    s_nop 7
    s_nop 3
    v_mul_f32 v48, 0xbfb8aa3b, v48
    v_mul_f32 v49, 0xbfb8aa3b, v49
    v_mul_f32 v50, 0xbfb8aa3b, v50
    v_mul_f32 v51, 0xbfb8aa3b, v51
    v_mul_f32 v52, 0xbfb8aa3b, v52
    v_mul_f32 v53, 0xbfb8aa3b, v53
    v_mul_f32 v54, 0xbfb8aa3b, v54
    v_mul_f32 v55, 0xbfb8aa3b, v55
    v_mul_f32 v56, 0xbfb8aa3b, v56
    v_mul_f32 v57, 0xbfb8aa3b, v57
    v_mul_f32 v58, 0xbfb8aa3b, v58
    v_mul_f32 v59, 0xbfb8aa3b, v59
    v_mul_f32 v60, 0xbfb8aa3b, v60
    v_mul_f32 v61, 0xbfb8aa3b, v61
    v_mul_f32 v62, 0xbfb8aa3b, v62
    v_mul_f32 v63, 0xbfb8aa3b, v63
    v_cvt_pk_bf16_f32 v48, v48, v49
    v_cvt_pk_bf16_f32 v49, v50, v51
    v_cvt_pk_bf16_f32 v50, v52, v53
    v_cvt_pk_bf16_f32 v51, v54, v55
    v_cvt_pk_bf16_f32 v52, v56, v57
    v_cvt_pk_bf16_f32 v53, v58, v59
    v_cvt_pk_bf16_f32 v54, v60, v61
    v_cvt_pk_bf16_f32 v55, v62, v63
    ds_write_b128 v17, v[48:51]
    ds_write_b128 v17, v[52:55] offset:1024
    v_bfe_u32 v56, v0, 4, 1
    v_and_b32 v57, 3, v0
    v_lshl_add_u32 v56, v56, 2, v57
    v_lshlrev_b32 v8, 20, v56
    v_mov_b64 v[36:37], 0
    v_mov_b64 v[38:39], 0
    v_mov_b64 v[96:97], 0
    v_mov_b64 v[98:99], 0
    v_mov_b64 v[100:101], 0
    v_mov_b64 v[102:103], 0
    v_mov_b64 v[104:105], 0
    v_mov_b64 v[106:107], 0
    v_mov_b64 v[108:109], 0
    v_mov_b64 v[110:111], 0
    v_mov_b64 v[112:113], 0
    v_mov_b64 v[114:115], 0
    v_mov_b64 v[116:117], 0
    v_mov_b64 v[118:119], 0
    v_mov_b64 v[120:121], 0
    v_mov_b64 v[122:123], 0
    v_mov_b64 v[124:125], 0
    v_mov_b64 v[126:127], 0
    s_movk_i32 s7, 144
    s_cmp_lg_u32 s63, 0
    s_cbranch_scc1 L_ss2
    v_lshrrev_b32 v56, 4, v0
    v_bfe_u32 v57, v0, 3, 1
    v_and_b32 v58, 7, v0
    v_lshlrev_b32 v32, 4, v56
    v_mad_u32_u24 v32, v58, s7, v32
    v_lshl_add_u32 v32, v57, 13, v32
    v_and_b32 v59, 4, v58
    v_add_u32 v59, v59, v58
    v_lshl_add_u32 v59, v57, 2, v59
    v_xor_b32 v33, v56, v59
    v_lshlrev_b32 v33, 4, v33
    v_lshl_add_u32 v33, v59, 8, v33
    v_add_u32 v33, 55296, v33
    v_and_b32 v57, 1, v56
    v_lshrrev_b32 v56, 1, v56
    v_lshlrev_b32 v58, 2, v56
    v_lshl_add_u32 v58, v57, 3, v58
    v_bfe_u32 v59, v0, 2, 2
    s_lshl_b32 s5, s100, 2
    v_add_u32 v59, s5, v59
    v_xor_b32 v59, v59, v58
    v_lshlrev_b32 v59, 4, v59
    v_lshl_add_u32 v59, v58, 8, v59
    v_and_b32 v58, 3, v0
    v_lshl_add_u32 v34, v58, 2, v59
    v_lshl_add_u32 v57, v57, 5, v56
    v_and_b32 v58, 15, v0
    s_lshl_b32 s6, s3, 8
    s_lshl_b32 s5, s100, 6
    s_add_u32 s6, s6, s5
    v_lshl_add_u32 v58, v58, 2, s6
    v_lshl_add_u32 v35, v57, 16, v58
L_ss2:
    v_mov_b32 v25, 0
    v_mov_b64 v[26:27], 0
    v_mov_b32 v29, 0
    v_mov_b64 v[30:31], 0
    v_mov_b32 v19, v13
    v_add_u32 v17, 0x400, v13
    v_add_u32 v15, 0x800, v13
    v_add_u32 v13, 0xc00, v13
    v_mov_b32 v45, 0x3fff
    v_mov_b64 v[46:47], 0
    v_lshlrev_b32 v14, 2, v2
    s_mov_b32 s72, 4194304
    s_branch L_sle
L_sl:
    s_sleep 1
    s_sub_u32 s72, s72, 1
    s_cbranch_scc1 L_sld
L_sle:
    ds_read_b32 v48, v44 offset:204
    s_waitcnt lgkmcnt(0)
    v_readfirstlane_b32 s30, v48
    s_cmp_lt_u32 s30, 4
    s_cbranch_scc1 L_sl
L_sld:
    ds_read_b32 v48, v14 offset:768
    ds_read_b64 v[50:51], v44 offset:144
    v_bfrev_b32 v53, 2
    s_waitcnt lgkmcnt(0)
    v_cmp_lt_u32_sdwa s[70:71], v2, v50 src0_sel:DWORD src1_sel:WORD_0
    v_and_b32 v49, 0x3ffff, v48
    v_lshlrev_b32 v49, 4, v49
    v_cndmask_b32 v49, v53, v49, s[70:71]
    buffer_load_dwordx4 v[64:67], v49, s[40:43], s73 offen sc1
    s_cmp_lg_u32 s4, 8
    s_cbranch_scc1 L_nlead
    ds_read_u16 v52, v22 offset:128
    v_readfirstlane_b32 s5, v50
    v_readfirstlane_b32 s6, v51
    s_movk_i32 s30, 88
    s_waitcnt lgkmcnt(0)
    v_and_b32 v58, 0xff, v52
    v_lshrrev_b32 v59, 8, v52
    v_add_u32 v52, v59, v58
    v_xor_b32 v53, v52, v20
    v_sub_u32 v53, v53, v20
    v_lshl_add_u32 v53, v52, 16, v53
    v_sub_u32 v94, 0, v52
    v_and_b32 v94, 31, v94
    v_add_u32_dpp v53, v53, v53 quad_perm:[1,0,3,2] row_mask:0xf bank_mask:0xf
    v_add_u32 v56, v94, v59
    v_cmp_lt_u32 vcc, 0x108, v56
    v_add_u32_dpp v53, v53, v53 quad_perm:[2,3,0,1] row_mask:0xf bank_mask:0xf
    v_cmp_lt_u32 s[68:69], s30, v58
    v_lshrrev_b32 v60, 1, v22
    v_add_u32_dpp v53, v53, v53 row_half_mirror row_mask:0xf bank_mask:0xf
    v_sub_u32 v94, v94, v23
    v_bfe_i32 v57, v53, 0, 16
    v_sub_u32 v53, v53, v57
    v_sub_u32 v56, 0, v57
    v_readfirstlane_b32 s7, v53
    v_max_i32 v57, v57, v56
    v_lshl_or_b32 v53, v57, 3, v23
    s_or_b64 vcc, vcc, s[68:69]
    s_cselect_b32 s6, 1, s6
    v_min_u32_dpp v53, v53, v53 row_ror:8 row_mask:0xf bank_mask:0xf
    s_xor_b32 s5, s5, s7
    s_cmp_gt_u32 s5, 0x400
    s_cselect_b32 s6, 1, s6
    s_lshl_b32 s14, s6, 31
    v_readlane_b32 s5, v53, 0
    v_readlane_b32 s6, v53, 16
    v_readlane_b32 s7, v53, 32
    v_readlane_b32 s30, v53, 48
    v_mul_u32_u24 v95, 0x160, v60
    v_add3_u32 v95, v95, v59, v23
    s_min_u32 s5, s5, s6
    s_min_u32 s7, s7, s30
    s_min_u32 s5, s5, s7
    s_lshl_b32 s5, s5, 1
    s_and_b32 s5, s5, 15
    s_lshl_b32 s6, s5, 24
    s_or_b32 s14, s14, s6
    v_lshrrev_b32 v56, 1, v60
    v_bfe_u32 v56, s5, v56, 1
    v_xor_b32 v56, v56, v60
    v_lshlrev_b32 v56, 2, v56
    v_lshl_or_b32 v52, v52, 3, v60
    v_lshl_or_b32 v52, v58, 16, v52
    v_or_b32 v52, s14, v52
    ds_write_b32 v56, v52 offset:54720
    v_lshlrev_b32 v95, 4, v95
L_nlead:
    s_branch L_p1
L_prep:
    s_mul_i32 s7, s4, 8
    s_add_u32 s7, s7, 44
    s_min_u32 s7, s7, 66
    s_lshl_b32 s7, s7, 10
    v_lshl_add_u32 v12, v0, 4, s7
    v_add_u32 v16, 88064, v12
    buffer_load_dwordx4 v[96:99], v12, s[36:39], 0 offen offset:0
    buffer_load_dwordx4 v[100:103], v12, s[36:39], 0 offen offset:1024
    buffer_load_dwordx4 v[104:107], v12, s[36:39], 0 offen offset:2048
    buffer_load_dwordx4 v[108:111], v12, s[36:39], 0 offen offset:3072
    v_add_u32 v12, 0x1000, v12
    buffer_load_dwordx4 v[112:115], v12, s[36:39], 0 offen offset:0
    buffer_load_dwordx4 v[116:119], v12, s[36:39], 0 offen offset:1024
    buffer_load_dwordx4 v[120:123], v12, s[36:39], 0 offen offset:2048
    buffer_load_dwordx4 v[124:127], v12, s[36:39], 0 offen offset:3072
    s_waitcnt vmcnt(7)
    ds_write_b128 v16, v[96:99] offset:0
    s_waitcnt vmcnt(6)
    ds_write_b128 v16, v[100:103] offset:1024
    s_waitcnt vmcnt(5)
    ds_write_b128 v16, v[104:107] offset:2048
    s_waitcnt vmcnt(4)
    ds_write_b128 v16, v[108:111] offset:3072
    s_waitcnt vmcnt(3)
    ds_write_b128 v16, v[112:115] offset:4096
    s_waitcnt vmcnt(2)
    ds_write_b128 v16, v[116:119] offset:5120
    s_waitcnt vmcnt(1)
    ds_write_b128 v16, v[120:123] offset:6144
    s_waitcnt vmcnt(0)
    ds_write_b128 v16, v[124:127] offset:7168
    s_lshl_b32 s5, s3, 4
    s_add_u32 s5, s5, 1048576
    v_lshl_add_u32 v62, v1, 12, s5
    s_andn2_b32 s6, 0xf800f800, s60
    s_mov_b32 s72, 0x100000
    s_movk_i32 s5, 784
    v_mul_u32_u24 v79, s5, v1
    v_lshl_or_b32 v79, v1, 20, v79
    s_mov_b32 s8, 0x05010400
    s_mov_b32 s9, 0x07030602
    s_mov_b32 s10, 0x05040100
    s_mov_b32 s11, 0x07060302
    s_waitcnt vmcnt(0)
    buffer_load_dwordx4 v[68:71], v62, s[40:43], 0 offen sc1
    s_mov_b64 exec, 1
    ds_add_u32 v44, v43 offset:196
    s_mov_b64 exec, -1
    v_bfe_u32 v56, v0, 4, 1
    v_and_b32 v57, 3, v0
    v_lshl_add_u32 v56, v56, 2, v57
    v_lshlrev_b32 v8, 20, v56
    v_mov_b64 v[36:37], 0
    v_mov_b64 v[38:39], 0
    v_mov_b64 v[96:97], 0
    v_mov_b64 v[98:99], 0
    v_mov_b64 v[100:101], 0
    v_mov_b64 v[102:103], 0
    v_mov_b64 v[104:105], 0
    v_mov_b64 v[106:107], 0
    v_mov_b64 v[108:109], 0
    v_mov_b64 v[110:111], 0
    v_mov_b64 v[112:113], 0
    v_mov_b64 v[114:115], 0
    v_mov_b64 v[116:117], 0
    v_mov_b64 v[118:119], 0
    v_mov_b64 v[120:121], 0
    v_mov_b64 v[122:123], 0
    v_mov_b64 v[124:125], 0
    v_mov_b64 v[126:127], 0
    s_movk_i32 s7, 144
    s_cmp_lg_u32 s63, 0
    s_cbranch_scc1 L_ss3
    v_lshrrev_b32 v56, 4, v0
    v_bfe_u32 v57, v0, 3, 1
    v_and_b32 v58, 7, v0
    v_lshlrev_b32 v32, 4, v56
    v_mad_u32_u24 v32, v58, s7, v32
    v_lshl_add_u32 v32, v57, 13, v32
    v_and_b32 v59, 4, v58
    v_add_u32 v59, v59, v58
    v_lshl_add_u32 v59, v57, 2, v59
    v_xor_b32 v33, v56, v59
    v_lshlrev_b32 v33, 4, v33
    v_lshl_add_u32 v33, v59, 8, v33
    v_add_u32 v33, 55296, v33
    v_and_b32 v57, 1, v56
    v_lshrrev_b32 v56, 1, v56
    v_lshlrev_b32 v58, 2, v56
    v_lshl_add_u32 v58, v57, 3, v58
    v_bfe_u32 v59, v0, 2, 2
    s_lshl_b32 s5, s100, 2
    v_add_u32 v59, s5, v59
    v_xor_b32 v59, v59, v58
    v_lshlrev_b32 v59, 4, v59
    v_lshl_add_u32 v59, v58, 8, v59
    v_and_b32 v58, 3, v0
    v_lshl_add_u32 v34, v58, 2, v59
    v_lshl_add_u32 v57, v57, 5, v56
    v_and_b32 v58, 15, v0
    s_lshl_b32 s6, s3, 8
    s_lshl_b32 s5, s100, 6
    s_add_u32 s6, s6, s5
    v_lshl_add_u32 v58, v58, 2, s6
    v_lshl_add_u32 v35, v57, 16, v58
L_ss3:
    v_mov_b32 v25, 0
    v_mov_b64 v[26:27], 0
    v_mov_b32 v29, 0
    v_mov_b64 v[30:31], 0
    v_mov_b32 v19, v13
    v_add_u32 v17, 0x400, v13
    v_add_u32 v15, 0x800, v13
    v_add_u32 v13, 0xc00, v13
    v_mov_b32 v45, 0x3fff
    v_mov_b64 v[46:47], 0
    v_lshlrev_b32 v14, 2, v2
    s_andn2_b32 s6, 0xf800f800, s60
L_poll:
    s_sub_u32 s72, s72, 1
    s_waitcnt vmcnt(0)
    v_and_b32 v72, 0xf800f800, v68
    v_cmp_ne_u32 vcc, s60, v71
    v_cmp_ne_u32 s[68:69], s6, v72
    s_cbranch_scc1 L_polled
    s_or_b64 exec, vcc, s[68:69]
    s_cbranch_execz L_polled
    buffer_load_dwordx4 v[68:71], v62, s[40:43], 0 offen sc1
    s_branch L_poll
L_polled:
    s_mov_b64 exec, -1
    v_bfe_u32 v91, v68, 16, 11
    v_and_b32 v85, 0x7ff, v68
    v_min_u32 v92, 24, v91
    v_add3_u32 v77, v85, v92, 1
    v_lshrrev_b32 v78, 1, v85
    v_lshrrev_b32 v76, 1, v77
    v_sub_u32 v76, v76, v78
    v_lshl_or_b32 v84, v92, 16, v76
    v_and_b32 v54, 0x0f0f0f0f, v69
    v_lshrrev_b32 v55, 4, v69
    v_add_u32_dpp v84, v84, v84 row_shr:1 row_mask:0xf bank_mask:0xf bound_ctrl:1
    v_and_b32 v56, 0x0f0f0f0f, v70
    v_lshrrev_b32 v57, 4, v70
    v_add_u32_dpp v84, v84, v84 row_shr:2 row_mask:0xf bank_mask:0xf bound_ctrl:1
    v_and_b32 v55, 0x0f0f0f0f, v55
    v_and_b32 v57, 0x0f0f0f0f, v57
    v_add_u32_dpp v84, v84, v84 row_shr:4 row_mask:0xf bank_mask:0xf bound_ctrl:1
    v_perm_b32 v58, v56, v54, s8
    v_perm_b32 v59, v56, v54, s9
    v_add_u32_dpp v84, v84, v84 row_shr:8 row_mask:0xf bank_mask:0xf bound_ctrl:1
    v_perm_b32 v60, v57, v55, s8
    v_perm_b32 v61, v57, v55, s9
    v_add_u32_dpp v84, v84, v84 row_bcast:15 row_mask:0xa bank_mask:0xf
    v_perm_b32 v72, v60, v58, s10
    v_perm_b32 v73, v60, v58, s11
    v_add_u32_dpp v84, v84, v84 row_bcast:31 row_mask:0xc bank_mask:0xf
    s_mov_b32 exec_lo, 0
    s_brev_b32 exec_hi, 1
    ds_add_rtn_u32 v90, v44, v84 offset:144
    s_mov_b64 exec, -1
    v_perm_b32 v74, v61, v59, s10
    v_perm_b32 v75, v61, v59, s11
    v_mov_b64 v[80:81], v[72:73]
    v_mov_b64 v[82:83], v[74:75]
    v_add_u32 v78, v78, v79
    v_add_u32_dpp v80, v80, v80 row_shr:1 row_mask:0xf bank_mask:0xf bound_ctrl:1
    v_add_u32_dpp v81, v81, v81 row_shr:1 row_mask:0xf bank_mask:0xf bound_ctrl:1
    v_add_u32_dpp v82, v82, v82 row_shr:1 row_mask:0xf bank_mask:0xf bound_ctrl:1
    v_add_u32_dpp v83, v83, v83 row_shr:1 row_mask:0xf bank_mask:0xf bound_ctrl:1
    v_add_u32_dpp v80, v80, v80 row_shr:2 row_mask:0xf bank_mask:0xf bound_ctrl:1
    v_add_u32_dpp v81, v81, v81 row_shr:2 row_mask:0xf bank_mask:0xf bound_ctrl:1
    v_add_u32_dpp v82, v82, v82 row_shr:2 row_mask:0xf bank_mask:0xf bound_ctrl:1
    v_add_u32_dpp v83, v83, v83 row_shr:2 row_mask:0xf bank_mask:0xf bound_ctrl:1
    v_add_u32_dpp v80, v80, v80 row_shr:4 row_mask:0xf bank_mask:0xf bound_ctrl:1
    v_add_u32_dpp v81, v81, v81 row_shr:4 row_mask:0xf bank_mask:0xf bound_ctrl:1
    v_add_u32_dpp v82, v82, v82 row_shr:4 row_mask:0xf bank_mask:0xf bound_ctrl:1
    v_add_u32_dpp v83, v83, v83 row_shr:4 row_mask:0xf bank_mask:0xf bound_ctrl:1
    v_add_u32_dpp v80, v80, v80 row_shr:8 row_mask:0xf bank_mask:0xf bound_ctrl:1
    v_add_u32_dpp v81, v81, v81 row_shr:8 row_mask:0xf bank_mask:0xf bound_ctrl:1
    v_add_u32_dpp v82, v82, v82 row_shr:8 row_mask:0xf bank_mask:0xf bound_ctrl:1
    v_add_u32_dpp v83, v83, v83 row_shr:8 row_mask:0xf bank_mask:0xf bound_ctrl:1
    v_add_u32_dpp v80, v80, v80 row_bcast:15 row_mask:0xa bank_mask:0xf
    v_add_u32_dpp v81, v81, v81 row_bcast:15 row_mask:0xa bank_mask:0xf
    v_add_u32_dpp v82, v82, v82 row_bcast:15 row_mask:0xa bank_mask:0xf
    v_add_u32_dpp v83, v83, v83 row_bcast:15 row_mask:0xa bank_mask:0xf
    v_add_u32_dpp v80, v80, v80 row_bcast:31 row_mask:0xc bank_mask:0xf
    v_add_u32_dpp v81, v81, v81 row_bcast:31 row_mask:0xc bank_mask:0xf
    v_add_u32_dpp v82, v82, v82 row_bcast:31 row_mask:0xc bank_mask:0xf
    v_add_u32_dpp v83, v83, v83 row_bcast:31 row_mask:0xc bank_mask:0xf
    s_mov_b32 exec_lo, 0
    s_brev_b32 exec_hi, 1
    ds_add_rtn_u64 v[86:87], v44, v[80:81] offset:128
    ds_add_rtn_u64 v[88:89], v44, v[82:83] offset:136
    s_mov_b64 exec, -1
    s_waitcnt lgkmcnt(2)
    v_readlane_b32 s31, v90, 63
    v_lshlrev_b32 v93, 30, v85
    v_not_b32 v77, v77
    v_add_u32 v84, s31, v84
    v_and_b32 v93, 0x40000000, v93
    v_and_b32 v84, 0xffff, v84
    v_lshlrev_b32 v77, 31, v77
    v_cmp_ge_u32 vcc, 0x400, v84
    v_sub_u32 v94, v84, v76
    v_lshlrev_b32 v94, 2, v94
    v_lshlrev_b32 v84, 2, v84
    v_or_b32 v93, v93, v78
    s_mov_b64 exec, vcc
    v_cmpx_lt_u32 s[68:69], 0, v76
    ds_write_b32 v94, v93 offset:768
    v_cmpx_lt_u32 vcc, 1, v76
    v_add_u32 v78, 1, v78
    ds_write_b32 v94, v78 offset:772
    v_cmpx_lt_u32 vcc, 2, v76
    v_add_u32 v78, 1, v78
    ds_write_b32 v94, v78 offset:776
    v_cmpx_lt_u32 vcc, 3, v76
    v_add_u32 v78, 1, v78
    ds_write_b32 v94, v78 offset:780
    v_cmpx_lt_u32 vcc, 4, v76
    v_add_u32 v78, 1, v78
    ds_write_b32 v94, v78 offset:784
    v_cmpx_lt_u32 vcc, 5, v76
    v_add_u32 v78, 1, v78
    ds_write_b32 v94, v78 offset:788
    v_cmpx_lt_u32 vcc, 6, v76
    v_add_u32 v78, 1, v78
    s_cbranch_execz L_listed
    ds_write_b32 v94, v78 offset:792
    v_cmpx_lt_u32 vcc, 7, v76
    v_add_u32 v78, 1, v78
    s_cbranch_execz L_listed
    ds_write_b32 v94, v78 offset:796
    v_cmpx_lt_u32 vcc, 8, v76
    v_add_u32 v78, 1, v78
    s_cbranch_execz L_listed
    ds_write_b32 v94, v78 offset:800
    v_cmpx_lt_u32 vcc, 9, v76
    v_add_u32 v78, 1, v78
    s_cbranch_execz L_listed
    ds_write_b32 v94, v78 offset:804
    v_cmpx_lt_u32 vcc, 10, v76
    v_add_u32 v78, 1, v78
    s_cbranch_execz L_listed
    ds_write_b32 v94, v78 offset:808
    v_cmpx_lt_u32 vcc, 11, v76
    v_add_u32 v78, 1, v78
    s_cbranch_execz L_listed
    ds_write_b32 v94, v78 offset:812
    v_cmpx_lt_u32 vcc, 12, v76
    v_add_u32 v78, 1, v78
    s_cbranch_execz L_listed
    ds_write_b32 v94, v78 offset:816
L_listed:
    s_mov_b64 exec, s[68:69]
    ds_or_b32 v84, v77 offset:764
    s_mov_b64 exec, -1
    v_add3_u32 v70, v54, v55, v56
    v_add_u32 v70, v70, v57
    v_sad_u8 v70, v70, 0, 0
    v_cmp_ne_u32 vcc, v70, v91
    v_cmp_lt_u32 s[68:69], 24, v91
    s_or_b64 exec, vcc, s[68:69]
    ds_write_b32 v44, v43 offset:148
    s_mov_b64 exec, 1
    ds_add_u32 v44, v43 offset:204
    s_mov_b64 exec, -1
    v_sub_u32 v80, v80, v72
    v_sub_u32 v81, v81, v73
    v_sub_u32 v82, v82, v74
    v_sub_u32 v83, v83, v75
    s_mov_b32 s72, 4194304
    s_branch L_sl2e
L_sl2:
    s_sleep 1
    s_sub_u32 s72, s72, 1
    s_cbranch_scc1 L_sl2d
L_sl2e:
    ds_read_b32 v48, v44 offset:204
    s_waitcnt lgkmcnt(0)
    v_readfirstlane_b32 s30, v48
    s_cmp_lt_u32 s30, 4
    s_cbranch_scc1 L_sl2
L_sl2d:
    ds_read_b32 v48, v14 offset:768
    ds_read_b64 v[50:51], v44 offset:144
    v_bfrev_b32 v53, 2
    s_waitcnt lgkmcnt(0)
    v_cmp_lt_u32_sdwa s[70:71], v2, v50 src0_sel:DWORD src1_sel:WORD_0
    v_and_b32 v49, 0x3ffff, v48
    v_lshlrev_b32 v49, 4, v49
    v_cndmask_b32 v49, v53, v49, s[70:71]
    buffer_load_dwordx4 v[64:67], v49, s[40:43], s73 offen sc1
    v_readlane_b32 s5, v86, 63
    v_readlane_b32 s6, v87, 63
    v_readlane_b32 s7, v88, 63
    v_readlane_b32 s30, v89, 63
    s_setprio 0
    v_add_u32 v80, s5, v80
    v_add_u32 v81, s6, v81
    v_add_u32 v82, s7, v82
    v_add_u32 v83, s30, v83
    s_mov_b32 s5, 0x00ff00ff
    v_mov_b32 v84, 0xffa0ffa1
    v_xad_u32 v80, v80, s5, v84
    v_xad_u32 v81, v81, s5, v84
    v_xad_u32 v82, v82, s5, v84
    v_xad_u32 v83, v83, s5, v84
    ds_write_b128 v18, v[80:83] offset:4864
L_p1:
    v_bfe_u32 v54, v48, 20, 8
    v_lshlrev_b32 v56, 1, v48
    v_cmp_le_i32 s[68:69], 0, v48
    v_cmp_le_i32 vcc, 0, v56
    v_lshlrev_b32 v54, 4, v54
    s_mov_b32 s31, 88064
    s_mov_b32 s8, 0xffc00000
    s_movk_i32 s9, 176
    v_mov_b32 v55, 472
    s_and_b64 s[12:13], s[68:69], s[70:71]
    s_and_b64 s[10:11], vcc, s[70:71]
    s_mov_b32 m0, s66
    s_waitcnt lgkmcnt(0)
    s_barrier
    ds_read_b32 v52, v21 offset:54720
    s_cmp_lg_u32 s63, 0
    s_cbranch_scc1 L_bu2
    s_lshl_b32 s5, s100, 10
    v_lshl_add_u32 v56, v0, 4, s5
    ds_write_b128 v56, v[32:35] offset:768
L_bu2:
    s_waitcnt vmcnt(0)
    v_bfi_b32 v56, s8, v64, v65
    v_bfi_b32 v57, s8, v66, v67
    v_bitop3_b32 v56, v56, v57, s75 bitop3:0x7e
    v_and_b32 v56, 0xffc0fff0, v56
    v_cmp_ne_u32 vcc, 0, v56
    s_waitcnt lgkmcnt(0)
    v_readfirstlane_b32 s16, v52
    s_and_b64 vcc, vcc, s[70:71]
    s_cbranch_scc1 L_rp
L_rpd:
    s_cmp_lt_i32 s16, 0
    s_cbranch_scc1 L_slow
    s_mov_b64 exec, 0x3ff
    buffer_load_dword v92, v40, s[48:51], s99 idxen offset:3072 sc1
    s_mov_b64 exec, s[10:11]
    v_and_b32 v75, 0x3fff, v64
    v_mad_u32_u24 v76, v75, 6, s31
    v_bfe_u32 v77, v64, 16, 6
    ds_read_u16_d16_hi v68, v76
    ds_read_u16_d16_hi v69, v76 offset:2
    ds_read_u16_d16_hi v70, v76 offset:4
    v_lshlrev_b32 v76, 3, v77
    ds_read_b64 v[72:73], v76 offset:54272
    v_bfe_u32 v78, v64, 15, 4
    v_add_u32 v76, v78, v54
    ds_read_u8 v71, v76 offset:4864
    s_mov_b64 exec, s[12:13]
    v_and_b32 v87, 0x3fff, v66
    v_mad_u32_u24 v88, v87, 6, s31
    v_bfe_u32 v89, v66, 16, 6
    ds_read_u16_d16_hi v80, v88
    ds_read_u16_d16_hi v81, v88 offset:2
    ds_read_u16_d16_hi v82, v88 offset:4
    v_lshlrev_b32 v88, 3, v89
    ds_read_b64 v[84:85], v88 offset:54272
    v_bfe_u32 v90, v66, 15, 4
    v_add_u32 v88, v90, v54
    ds_read_u8 v83, v88 offset:4864
    s_mov_b64 exec, -1
    s_and_b32 s6, s16, 7
    s_bfe_u32 s64, s16, 0xa0003
    s_bfe_u32 s7, s16, 0x80010
    s_lshr_b32 s98, s16, 24
    s_sub_u32 s30, s6, s61
    s_mov_b32 s61, s6
    s_mul_i32 s6, s30, 352
    s_sub_u32 s6, s6, s7
    s_lshl_b32 s6, s6, 4
    s_lshl_b32 s5, s30, 9
    v_add_u32 v53, s5, v3
    s_mul_i32 s7, s30, 1536
    v_add_u32 v6, s6, v6
    v_add_u32 v9, s6, v9
    v_add_u32 v7, s6, v7
    v_add_u32 v11, s7, v11
    s_add_u32 s5, s64, 31
    s_lshr_b32 s65, s5, 5
    v_and_b32 v76, 15, v65
    v_mad_u32_u24 v78, v78, s9, v55
    v_lshrrev_b32 v77, 3, v77
    v_and_b32 v74, 0xffff0000, v65
    v_lshl_or_b32 v57, v77, 20, v75
    v_mul_f32 v74, 0xbfb8aa3b, v74
    s_waitcnt lgkmcnt(5)
    v_lshlrev_b32 v75, 16, v72
    v_and_b32 v72, 0xffff0000, v72
    v_sub_f32 v70, v73, v70
    v_sub_f32 v68, v75, v68
    v_sub_f32 v69, v72, v69
    v_mul_f32 v72, v70, v70
    v_fmac_f32 v72, v68, v68
    v_cvt_pk_bf16_f32 v58, 1.0, v68
    v_fmac_f32 v72, v69, v69
    v_cvt_pk_bf16_f32 v59, v69, v70
    v_mul_f32 v72, 0xbfb8aa3b, v72
    v_cvt_pk_bf16_f32 v56, v72, v74
    v_add3_u32 v71, v71, v76, v78
    v_lshlrev_b32 v71, 4, v71
    s_mov_b64 exec, s[10:11]
    ds_write_b128 v71, v[56:59]
    s_mov_b64 exec, -1
    v_and_b32 v88, 15, v67
    v_mad_u32_u24 v90, v90, s9, v55
    v_lshrrev_b32 v89, 3, v89
    v_and_b32 v86, 0xffff0000, v67
    v_lshl_or_b32 v61, v89, 20, v87
    v_mul_f32 v86, 0xbfb8aa3b, v86
    s_waitcnt lgkmcnt(1)
    v_lshlrev_b32 v87, 16, v84
    v_and_b32 v84, 0xffff0000, v84
    v_sub_f32 v82, v85, v82
    v_sub_f32 v80, v87, v80
    v_sub_f32 v81, v84, v81
    v_mul_f32 v84, v82, v82
    v_fmac_f32 v84, v80, v80
    v_cvt_pk_bf16_f32 v62, 1.0, v80
    v_fmac_f32 v84, v81, v81
    v_cvt_pk_bf16_f32 v63, v81, v82
    v_mul_f32 v84, 0xbfb8aa3b, v84
    v_cvt_pk_bf16_f32 v60, v84, v86
    v_add3_u32 v83, v83, v88, v90
    v_lshlrev_b32 v83, 4, v83
    s_mov_b64 exec, s[12:13]
    ds_write_b128 v83, v[60:63]
    s_mov_b64 exec, -1
    s_cmp_lg_u32 s4, 7
    s_cbranch_scc1 L_nfp
    s_setprio 3
    v_lshlrev_b32 v72, 4, v0
    s_mov_b32 s72, 0x100000
    s_and_b32 s14, s2, 7
    s_lshl_b32 s14, s14, 10
    s_add_u32 s14, s14, 10616832
L_fp:
    buffer_load_dwordx4 v[68:71], v72, s[40:43], s14 offen sc1
    s_sub_u32 s72, s72, 1
    s_waitcnt vmcnt(0)
    s_cbranch_scc1 L_fpd
    v_xor_b32 v68, s60, v68
    v_xor_b32 v69, s60, v69
    v_xor_b32 v70, s60, v70
    v_xor_b32 v71, s60, v71
    v_or3_b32 v68, v68, v69, v70
    v_or_b32 v68, v68, v71
    v_cmp_ne_u32 vcc, 0, v68
    s_and_b64 exec, exec, vcc
    s_cbranch_execz L_fpd
    s_branch L_fp
L_fpd:
    s_mov_b64 exec, -1
L_nfp:
    s_cmp_lg_u32 s4, 8
    s_cbranch_scc1 L_npad
    v_cmpx_lt_i32 vcc, 0, v94
    ds_write_b128 v95, v[44:47] offset:10368
    v_cmpx_lt_i32 vcc, 8, v94
    ds_write_b128 v95, v[44:47] offset:10496
    v_cmpx_lt_i32 vcc, 16, v94
    ds_write_b128 v95, v[44:47] offset:10624
    v_cmpx_lt_i32 vcc, 24, v94
    ds_write_b128 v95, v[44:47] offset:10752
    s_mov_b64 exec, -1
L_npad:
L_go0:
    s_setprio 3
    s_waitcnt lgkmcnt(0)
    s_barrier
    ds_read_u16 v12, v7 offset:4
    ds_read_u16 v14, v7 offset:132
    ds_read_u16 v16, v7 offset:260
    ds_read_u16 v18, v7 offset:388
    ds_read_u16 v3, v6 offset:6
    s_cmp_eq_u32 s65, 0
    s_cbranch_scc1 L_empty
    s_waitcnt lgkmcnt(1)
    buffer_load_dwordx4 v[12:13], s[48:51], 0 idxen offen offset:0 sc1 lds
    buffer_load_dwordx4 v[14:15], s[48:51], 0 idxen offen offset:1024 sc1 lds
    buffer_load_dwordx4 v[16:17], s[48:51], 0 idxen offen offset:2048 sc1 lds
    buffer_load_dwordx4 v[18:19], s[48:51], 0 idxen offen offset:3072 sc1 lds
    ds_read_u16 v12, v7 offset:516
    ds_read_u16 v14, v7 offset:644
    ds_read_u16 v16, v7 offset:772
    ds_read_u16 v18, v7 offset:900
    ds_read_u16_d16_hi v34, v9 offset:6
    ds_read_u16_d16_hi v35, v9 offset:134
    v_mov_b32 v21, 0
    v_mov_b64 v[22:23], 0
    s_waitcnt lgkmcnt(6)
    s_mov_b32 exec_lo, 0
    ds_read_b128 v[20:23], v3
    s_not_b64 exec, exec
    ds_read_b32 v20, v6 offset:0
    s_mov_b64 exec, -1
    s_cmp_lg_u32 s101, 0
    s_cbranch_scc1 L_nyp
    s_mov_b32 exec_lo, 0
    ds_read_b128 v[24:27], v53
    ds_read_b128 v[28:31], v53 offset:4096
    s_not_b64 exec, exec
    ds_read_b32 v24, v41 offset:54784
    ds_read_b32 v28, v41 offset:54912
    s_mov_b64 exec, -1
L_nyp:
    s_sub_i32 s10, 8, s65
    s_max_i32 s10, s10, 0
    s_lshl_b32 s10, s10, 9
    v_mov_b64 v[88:89], 0
    v_mov_b64 v[90:91], 0
    s_add_u32 s5, s64, 31
    s_bfe_u32 s74, s5, 0x30002
    v_subrev_u32 v9, s10, v9
    v_subrev_u32 v6, s10, v6
    v_subrev_u32 v7, s10, v7
    v_sub_f32 v8, v9, v8
    s_cmp_lt_u32 s65, 2
    s_waitcnt vmcnt(0)
    ds_read_b64_tr_b16 v[64:65], v4 offset:0
    ds_read_b64_tr_b16 v[66:67], v4 offset:256
    ds_read_b64_tr_b16 v[68:69], v4 offset:1024
    ds_read_b64_tr_b16 v[70:71], v4 offset:1280
    ds_read_b64_tr_b16 v[72:73], v4 offset:2048
    ds_read_b64_tr_b16 v[74:75], v4 offset:2304
    ds_read_b64_tr_b16 v[76:77], v4 offset:3072
    ds_read_b64_tr_b16 v[78:79], v4 offset:3328
    ds_read_b64_tr_b16 v[40:41], v4 offset:64
    ds_read_b64_tr_b16 v[42:43], v4 offset:320
    ds_read_b64_tr_b16 v[44:45], v4 offset:1088
    ds_read_b64_tr_b16 v[46:47], v4 offset:1344
    ds_read_b64_tr_b16 v[48:49], v4 offset:2112
    ds_read_b64_tr_b16 v[50:51], v4 offset:2368
    ds_read_b64_tr_b16 v[52:53], v4 offset:3136
    s_waitcnt lgkmcnt(7)
    v_mfma_f32_32x32x16_bf16 v[64:79], v[20:23], v[24:27], v[64:79]
    ds_read_b64_tr_b16 v[54:55], v4 offset:3392
    s_cbranch_scc1 L_one
    s_waitcnt lgkmcnt(0)
    buffer_load_dwordx4 v[12:13], s[48:51], 0 idxen offen offset:0 sc1 lds
    buffer_load_dwordx4 v[14:15], s[48:51], 0 idxen offen offset:1024 sc1 lds
    buffer_load_dwordx4 v[16:17], s[48:51], 0 idxen offen offset:2048 sc1 lds
    buffer_load_dwordx4 v[18:19], s[48:51], 0 idxen offen offset:3072 sc1 lds
    s_nop 2
    s_cmp_eq_u32 s65, 7
    s_cbranch_scc1 L_u1
    s_cmp_eq_u32 s65, 6
    s_cbranch_scc1 L_u2
    s_cmp_eq_u32 s65, 8
    s_cbranch_scc1 L_u0
    s_cmp_eq_u32 s65, 5
    s_cbranch_scc1 L_u3
    s_cmp_eq_u32 s65, 4
    s_cbranch_scc1 L_u4
    s_cmp_eq_u32 s65, 3
    s_cbranch_scc1 L_u5
    s_cmp_eq_u32 s65, 2
    s_cbranch_scc1 L_u6
    s_movk_i32 s8, 0x200
    s_movk_i32 s9, 0x200
    s_sub_u32 s65, s65, 9
    s_nop 0
L_tile:
    v_exp_f32_e64 v56, v64
    v_exp_f32 v57, v65
    s_waitcnt lgkmcnt(0)
    v_mfma_f32_32x32x16_bf16 v[112:127], v[88:91], v[36:39], v[112:127]
    v_exp_f32 v58, v66
    v_exp_f32 v59, v67
    v_exp_f32 v60, v68
    v_exp_f32 v61, v69
    v_exp_f32 v62, v70
    v_exp_f32 v63, v71
    v_pk_add_f32 v[56:57], v[56:57], 1.0 op_sel_hi:[1,0]
    v_pk_add_f32 v[58:59], v[58:59], 1.0 op_sel_hi:[1,0]
    v_pk_add_f32 v[60:61], v[60:61], 1.0 op_sel_hi:[1,0]
    v_pk_add_f32 v[62:63], v[62:63], 1.0 op_sel_hi:[1,0]
    v_pk_add_f32 v[34:35], v[34:35], v[8:9] op_sel_hi:[1,0]
    ds_read_u16_d16_hi v38, v9 offset:262
    ds_read_u16_d16_hi v39, v9 offset:390
    ds_read_b64_tr_b16 v[32:33], v34 offset:8
    ds_read_b64_tr_b16 v[34:35], v35 offset:136
    v_mfma_f32_32x32x16_bf16 v[80:95], v[20:23], v[28:31], v[40:55]
    v_rcp_f32 v56, v56
    v_rcp_f32 v57, v57
    v_rcp_f32 v58, v58
    v_rcp_f32 v59, v59
    v_rcp_f32 v60, v60
    v_rcp_f32 v61, v61
    v_rcp_f32 v62, v62
    v_rcp_f32 v63, v63
    v_pk_mul_f32 v[56:57], v[56:57], v[64:65]
    v_pk_mul_f32 v[58:59], v[58:59], v[66:67]
    v_pk_mul_f32 v[60:61], v[60:61], v[68:69]
    v_pk_mul_f32 v[62:63], v[62:63], v[70:71]
    ds_read_u16 v3, v6 offset:518
    v_cvt_pk_bf16_f32 v64, v56, v57
    v_cvt_pk_bf16_f32 v65, v58, v59
    v_cvt_pk_bf16_f32 v66, v60, v61
    v_cvt_pk_bf16_f32 v67, v62, v63
    v_exp_f32_e64 v56, v72
    v_exp_f32 v57, v73
    s_waitcnt lgkmcnt(1)
    v_mfma_f32_32x32x16_bf16 v[96:111], v[64:67], v[32:35], v[96:111]
    v_exp_f32 v58, v74
    v_exp_f32 v59, v75
    v_exp_f32 v60, v76
    v_exp_f32 v61, v77
    v_exp_f32 v62, v78
    v_exp_f32 v63, v79
    v_pk_add_f32 v[56:57], v[56:57], 1.0 op_sel_hi:[1,0]
    v_pk_add_f32 v[58:59], v[58:59], 1.0 op_sel_hi:[1,0]
    v_pk_add_f32 v[60:61], v[60:61], 1.0 op_sel_hi:[1,0]
    v_pk_add_f32 v[62:63], v[62:63], 1.0 op_sel_hi:[1,0]
    v_pk_add_f32 v[38:39], v[38:39], v[8:9] op_sel_hi:[1,0]
    ds_read_b64_tr_b16 v[36:37], v38 offset:264
    ds_read_b64_tr_b16 v[38:39], v39 offset:392
    s_waitcnt lgkmcnt(2)
    s_mov_b32 exec_lo, 0
    ds_read_b128 v[20:23], v3
    s_not_b64 exec, exec
    ds_read_b32 v20, v6 offset:512
    s_mov_b64 exec, -1
    v_rcp_f32 v56, v56
    v_rcp_f32 v57, v57
    v_rcp_f32 v58, v58
    v_rcp_f32 v59, v59
    v_rcp_f32 v60, v60
    v_rcp_f32 v61, v61
    v_rcp_f32 v62, v62
    v_rcp_f32 v63, v63
    v_pk_mul_f32 v[56:57], v[56:57], v[72:73]
    v_pk_mul_f32 v[58:59], v[58:59], v[74:75]
    v_pk_mul_f32 v[60:61], v[60:61], v[76:77]
    v_pk_mul_f32 v[62:63], v[62:63], v[78:79]
    ds_read_u16 v12, v7 offset:1028
    ds_read_u16 v14, v7 offset:1156
    ds_read_u16 v16, v7 offset:1284
    ds_read_u16 v18, v7 offset:1412
    v_cvt_pk_bf16_f32 v72, v56, v57
    v_cvt_pk_bf16_f32 v73, v58, v59
    v_cvt_pk_bf16_f32 v74, v60, v61
    v_cvt_pk_bf16_f32 v75, v62, v63
    v_exp_f32_e64 v56, v80
    v_exp_f32 v57, v81
    s_waitcnt lgkmcnt(6)
    v_mfma_f32_32x32x16_bf16 v[96:111], v[72:75], v[36:39], v[96:111]
    v_exp_f32 v58, v82
    v_exp_f32 v59, v83
    v_exp_f32 v60, v84
    v_exp_f32 v61, v85
    v_exp_f32 v62, v86
    v_exp_f32 v63, v87
    v_pk_add_f32 v[56:57], v[56:57], 1.0 op_sel_hi:[1,0]
    v_pk_add_f32 v[58:59], v[58:59], 1.0 op_sel_hi:[1,0]
    v_pk_add_f32 v[60:61], v[60:61], 1.0 op_sel_hi:[1,0]
    v_pk_add_f32 v[62:63], v[62:63], 1.0 op_sel_hi:[1,0]
    v_rcp_f32 v56, v56
    v_rcp_f32 v57, v57
    v_rcp_f32 v58, v58
    v_rcp_f32 v59, v59
    v_rcp_f32 v60, v60
    v_rcp_f32 v61, v61
    v_rcp_f32 v62, v62
    v_rcp_f32 v63, v63
    v_pk_mul_f32 v[56:57], v[56:57], v[80:81]
    v_pk_mul_f32 v[58:59], v[58:59], v[82:83]
    v_pk_mul_f32 v[60:61], v[60:61], v[84:85]
    v_pk_mul_f32 v[62:63], v[62:63], v[86:87]
    s_waitcnt vmcnt(0)
    ds_read_b64_tr_b16 v[64:65], v4 offset:0
    ds_read_b64_tr_b16 v[66:67], v4 offset:256
    ds_read_b64_tr_b16 v[68:69], v4 offset:1024
    ds_read_b64_tr_b16 v[70:71], v4 offset:1280
    ds_read_b64_tr_b16 v[72:73], v4 offset:2048
    ds_read_b64_tr_b16 v[74:75], v4 offset:2304
    ds_read_b64_tr_b16 v[76:77], v4 offset:3072
    ds_read_b64_tr_b16 v[78:79], v4 offset:3328
    v_cvt_pk_bf16_f32 v80, v56, v57
    v_cvt_pk_bf16_f32 v81, v58, v59
    v_cvt_pk_bf16_f32 v82, v60, v61
    v_cvt_pk_bf16_f32 v83, v62, v63
    v_exp_f32 v56, v88
    v_exp_f32_e64 v57, v89
    v_mfma_f32_32x32x16_bf16 v[112:127], v[80:83], v[32:35], v[112:127]
    v_exp_f32 v58, v90
    v_exp_f32 v59, v91
    v_exp_f32 v60, v92
    v_exp_f32 v61, v93
    v_exp_f32 v62, v94
    v_exp_f32 v63, v95
    v_pk_add_f32 v[56:57], v[56:57], 1.0 op_sel_hi:[1,0]
    v_pk_add_f32 v[58:59], v[58:59], 1.0 op_sel_hi:[1,0]
    v_pk_add_f32 v[60:61], v[60:61], 1.0 op_sel_hi:[1,0]
    v_pk_add_f32 v[62:63], v[62:63], 1.0 op_sel_hi:[1,0]
    v_pk_add_f32 v[6:7], v[6:7], s[8:9]
    v_pk_add_f32 v[8:9], v[8:9], s[8:9]
    ds_read_b64_tr_b16 v[40:41], v4 offset:64
    ds_read_b64_tr_b16 v[42:43], v4 offset:320
    ds_read_b64_tr_b16 v[44:45], v4 offset:1088
    ds_read_b64_tr_b16 v[46:47], v4 offset:1344
    ds_read_b64_tr_b16 v[48:49], v4 offset:2112
    ds_read_b64_tr_b16 v[50:51], v4 offset:2368
    ds_read_b64_tr_b16 v[52:53], v4 offset:3136
    ds_read_b64_tr_b16 v[54:55], v4 offset:3392
    s_waitcnt lgkmcnt(8)
    v_mfma_f32_32x32x16_bf16 v[64:79], v[20:23], v[24:27], v[64:79]
    v_rcp_f32 v56, v56
    v_rcp_f32 v57, v57
    v_rcp_f32 v58, v58
    v_rcp_f32 v59, v59
    v_rcp_f32 v60, v60
    v_rcp_f32 v61, v61
    v_rcp_f32 v62, v62
    v_rcp_f32_e64 v63, v63
    v_pk_mul_f32 v[56:57], v[56:57], v[88:89]
    v_pk_mul_f32 v[58:59], v[58:59], v[90:91]
    v_pk_mul_f32 v[60:61], v[60:61], v[92:93]
    v_pk_mul_f32 v[62:63], v[62:63], v[94:95]
    ds_read_u16_d16_hi v34, v9 offset:6
    ds_read_u16_d16_hi v35, v9 offset:134
    s_waitcnt lgkmcnt(2)
    buffer_load_dwordx4 v[12:13], s[48:51], 0 idxen offen offset:0 sc1 lds
    buffer_load_dwordx4 v[14:15], s[48:51], 0 idxen offen offset:1024 sc1 lds
    buffer_load_dwordx4 v[16:17], s[48:51], 0 idxen offen offset:2048 sc1 lds
    buffer_load_dwordx4 v[18:19], s[48:51], 0 idxen offen offset:3072 sc1 lds
    s_sub_u32 s65, s65, 1
    v_cvt_pk_bf16_f32 v88, v56, v57
    v_cvt_pk_bf16_f32 v89, v58, v59
    v_cvt_pk_bf16_f32 v90, v60, v61
    v_cvt_pk_bf16_f32 v91, v62, v63
    s_cbranch_scc0 L_tile
L_u0:
    v_exp_f32 v56, v64
    v_exp_f32 v57, v65
    s_waitcnt lgkmcnt(0)
    v_mfma_f32_32x32x16_bf16 v[112:127], v[88:91], v[36:39], v[112:127]
    v_exp_f32 v58, v66
    v_exp_f32 v59, v67
    v_exp_f32 v60, v68
    v_exp_f32 v61, v69
    v_exp_f32 v62, v70
    v_exp_f32 v63, v71
    v_pk_add_f32 v[56:57], v[56:57], 1.0 op_sel_hi:[1,0]
    v_pk_add_f32 v[58:59], v[58:59], 1.0 op_sel_hi:[1,0]
    v_pk_add_f32 v[60:61], v[60:61], 1.0 op_sel_hi:[1,0]
    v_pk_add_f32 v[62:63], v[62:63], 1.0 op_sel_hi:[1,0]
    v_pk_add_f32 v[34:35], v[34:35], v[8:9] op_sel_hi:[1,0]
    ds_read_u16_d16_hi v38, v9 offset:262
    ds_read_u16_d16_hi v39, v9 offset:390
    ds_read_b64_tr_b16 v[32:33], v34 offset:8
    ds_read_b64_tr_b16 v[34:35], v35 offset:136
    v_mfma_f32_32x32x16_bf16 v[80:95], v[20:23], v[28:31], v[40:55]
    v_rcp_f32 v56, v56
    v_rcp_f32 v57, v57
    v_rcp_f32 v58, v58
    v_rcp_f32 v59, v59
    v_rcp_f32 v60, v60
    v_rcp_f32 v61, v61
    v_rcp_f32 v62, v62
    v_rcp_f32 v63, v63
    v_pk_mul_f32 v[56:57], v[56:57], v[64:65]
    v_pk_mul_f32 v[58:59], v[58:59], v[66:67]
    v_pk_mul_f32 v[60:61], v[60:61], v[68:69]
    v_pk_mul_f32 v[62:63], v[62:63], v[70:71]
    ds_read_u16 v3, v6 offset:518
    v_cvt_pk_bf16_f32 v64, v56, v57
    v_cvt_pk_bf16_f32 v65, v58, v59
    v_cvt_pk_bf16_f32 v66, v60, v61
    v_cvt_pk_bf16_f32 v67, v62, v63
    v_exp_f32_e64 v56, v72
    v_exp_f32 v57, v73
    s_waitcnt lgkmcnt(1)
    v_mfma_f32_32x32x16_bf16 v[96:111], v[64:67], v[32:35], v[96:111]
    v_exp_f32 v58, v74
    v_exp_f32 v59, v75
    v_exp_f32 v60, v76
    v_exp_f32 v61, v77
    v_exp_f32 v62, v78
    v_exp_f32 v63, v79
    v_pk_add_f32 v[56:57], v[56:57], 1.0 op_sel_hi:[1,0]
    v_pk_add_f32 v[58:59], v[58:59], 1.0 op_sel_hi:[1,0]
    v_pk_add_f32 v[60:61], v[60:61], 1.0 op_sel_hi:[1,0]
    v_pk_add_f32 v[62:63], v[62:63], 1.0 op_sel_hi:[1,0]
    v_pk_add_f32 v[38:39], v[38:39], v[8:9] op_sel_hi:[1,0]
    ds_read_b64_tr_b16 v[36:37], v38 offset:264
    ds_read_b64_tr_b16 v[38:39], v39 offset:392
    s_waitcnt lgkmcnt(2)
    s_mov_b32 exec_lo, 0
    ds_read_b128 v[20:23], v3
    s_not_b64 exec, exec
    ds_read_b32 v20, v6 offset:512
    s_mov_b64 exec, -1
    v_rcp_f32 v56, v56
    v_rcp_f32 v57, v57
    v_rcp_f32 v58, v58
    v_rcp_f32 v59, v59
    v_rcp_f32 v60, v60
    v_rcp_f32 v61, v61
    v_rcp_f32 v62, v62
    v_rcp_f32 v63, v63
    v_pk_mul_f32 v[56:57], v[56:57], v[72:73]
    v_pk_mul_f32 v[58:59], v[58:59], v[74:75]
    v_pk_mul_f32 v[60:61], v[60:61], v[76:77]
    v_pk_mul_f32 v[62:63], v[62:63], v[78:79]
    ds_read_u16 v12, v7 offset:1028
    ds_read_u16 v14, v7 offset:1156
    ds_read_u16 v16, v7 offset:1284
    ds_read_u16 v18, v7 offset:1412
    v_cvt_pk_bf16_f32 v72, v56, v57
    v_cvt_pk_bf16_f32 v73, v58, v59
    v_cvt_pk_bf16_f32 v74, v60, v61
    v_cvt_pk_bf16_f32 v75, v62, v63
    v_exp_f32_e64 v56, v80
    v_exp_f32 v57, v81
    s_waitcnt lgkmcnt(6)
    v_mfma_f32_32x32x16_bf16 v[96:111], v[72:75], v[36:39], v[96:111]
    v_exp_f32 v58, v82
    v_exp_f32 v59, v83
    v_exp_f32 v60, v84
    v_exp_f32 v61, v85
    v_exp_f32 v62, v86
    v_exp_f32 v63, v87
    v_pk_add_f32 v[56:57], v[56:57], 1.0 op_sel_hi:[1,0]
    v_pk_add_f32 v[58:59], v[58:59], 1.0 op_sel_hi:[1,0]
    v_pk_add_f32 v[60:61], v[60:61], 1.0 op_sel_hi:[1,0]
    v_pk_add_f32 v[62:63], v[62:63], 1.0 op_sel_hi:[1,0]
    v_rcp_f32 v56, v56
    v_rcp_f32 v57, v57
    v_rcp_f32 v58, v58
    v_rcp_f32 v59, v59
    v_rcp_f32 v60, v60
    v_rcp_f32 v61, v61
    v_rcp_f32 v62, v62
    v_rcp_f32 v63, v63
    v_pk_mul_f32 v[56:57], v[56:57], v[80:81]
    v_pk_mul_f32 v[58:59], v[58:59], v[82:83]
    v_pk_mul_f32 v[60:61], v[60:61], v[84:85]
    v_pk_mul_f32 v[62:63], v[62:63], v[86:87]
    s_waitcnt vmcnt(0)
    ds_read_b64_tr_b16 v[64:65], v4 offset:0
    ds_read_b64_tr_b16 v[66:67], v4 offset:256
    ds_read_b64_tr_b16 v[68:69], v4 offset:1024
    ds_read_b64_tr_b16 v[70:71], v4 offset:1280
    ds_read_b64_tr_b16 v[72:73], v4 offset:2048
    ds_read_b64_tr_b16 v[74:75], v4 offset:2304
    ds_read_b64_tr_b16 v[76:77], v4 offset:3072
    ds_read_b64_tr_b16 v[78:79], v4 offset:3328
    v_cvt_pk_bf16_f32 v80, v56, v57
    v_cvt_pk_bf16_f32 v81, v58, v59
    v_cvt_pk_bf16_f32 v82, v60, v61
    v_cvt_pk_bf16_f32 v83, v62, v63
    v_exp_f32 v56, v88
    v_exp_f32_e64 v57, v89
    v_mfma_f32_32x32x16_bf16 v[112:127], v[80:83], v[32:35], v[112:127]
    v_exp_f32 v58, v90
    v_exp_f32 v59, v91
    v_exp_f32 v60, v92
    v_exp_f32 v61, v93
    v_exp_f32 v62, v94
    v_exp_f32 v63, v95
    v_pk_add_f32 v[56:57], v[56:57], 1.0 op_sel_hi:[1,0]
    v_pk_add_f32 v[58:59], v[58:59], 1.0 op_sel_hi:[1,0]
    v_pk_add_f32 v[60:61], v[60:61], 1.0 op_sel_hi:[1,0]
    v_pk_add_f32 v[62:63], v[62:63], 1.0 op_sel_hi:[1,0]
    ds_read_b64_tr_b16 v[40:41], v4 offset:64
    ds_read_b64_tr_b16 v[42:43], v4 offset:320
    ds_read_b64_tr_b16 v[44:45], v4 offset:1088
    ds_read_b64_tr_b16 v[46:47], v4 offset:1344
    ds_read_b64_tr_b16 v[48:49], v4 offset:2112
    ds_read_b64_tr_b16 v[50:51], v4 offset:2368
    ds_read_b64_tr_b16 v[52:53], v4 offset:3136
    ds_read_b64_tr_b16 v[54:55], v4 offset:3392
    s_waitcnt lgkmcnt(8)
    v_mfma_f32_32x32x16_bf16 v[64:79], v[20:23], v[24:27], v[64:79]
    v_rcp_f32 v56, v56
    v_rcp_f32 v57, v57
    v_rcp_f32 v58, v58
    v_rcp_f32 v59, v59
    v_rcp_f32 v60, v60
    v_rcp_f32 v61, v61
    v_rcp_f32 v62, v62
    v_rcp_f32_e64 v63, v63
    v_pk_mul_f32 v[56:57], v[56:57], v[88:89]
    v_pk_mul_f32 v[58:59], v[58:59], v[90:91]
    v_pk_mul_f32 v[60:61], v[60:61], v[92:93]
    v_pk_mul_f32 v[62:63], v[62:63], v[94:95]
    ds_read_u16_d16_hi v34, v9 offset:518
    ds_read_u16_d16_hi v35, v9 offset:646
    s_waitcnt lgkmcnt(2)
    buffer_load_dwordx4 v[12:13], s[48:51], 0 idxen offen offset:0 sc1 lds
    buffer_load_dwordx4 v[14:15], s[48:51], 0 idxen offen offset:1024 sc1 lds
    buffer_load_dwordx4 v[16:17], s[48:51], 0 idxen offen offset:2048 sc1 lds
    buffer_load_dwordx4 v[18:19], s[48:51], 0 idxen offen offset:3072 sc1 lds
    v_cvt_pk_bf16_f32 v88, v56, v57
    v_cvt_pk_bf16_f32 v89, v58, v59
    v_cvt_pk_bf16_f32 v90, v60, v61
    v_cvt_pk_bf16_f32 v91, v62, v63
L_u1:
    v_exp_f32 v56, v64
    v_exp_f32 v57, v65
    s_waitcnt lgkmcnt(0)
    v_mfma_f32_32x32x16_bf16 v[112:127], v[88:91], v[36:39], v[112:127]
    v_exp_f32 v58, v66
    v_exp_f32 v59, v67
    v_exp_f32 v60, v68
    v_exp_f32 v61, v69
    v_exp_f32 v62, v70
    v_exp_f32 v63, v71
    v_pk_add_f32 v[56:57], v[56:57], 1.0 op_sel_hi:[1,0]
    v_pk_add_f32 v[58:59], v[58:59], 1.0 op_sel_hi:[1,0]
    v_pk_add_f32 v[60:61], v[60:61], 1.0 op_sel_hi:[1,0]
    v_pk_add_f32 v[62:63], v[62:63], 1.0 op_sel_hi:[1,0]
    v_pk_add_f32 v[34:35], v[34:35], v[8:9] op_sel_hi:[1,0]
    ds_read_u16_d16_hi v38, v9 offset:774
    ds_read_u16_d16_hi v39, v9 offset:902
    ds_read_b64_tr_b16 v[32:33], v34 offset:520
    ds_read_b64_tr_b16 v[34:35], v35 offset:648
    v_mfma_f32_32x32x16_bf16 v[80:95], v[20:23], v[28:31], v[40:55]
    v_rcp_f32 v56, v56
    v_rcp_f32 v57, v57
    v_rcp_f32 v58, v58
    v_rcp_f32 v59, v59
    v_rcp_f32 v60, v60
    v_rcp_f32 v61, v61
    v_rcp_f32 v62, v62
    v_rcp_f32 v63, v63
    v_pk_mul_f32 v[56:57], v[56:57], v[64:65]
    v_pk_mul_f32 v[58:59], v[58:59], v[66:67]
    v_pk_mul_f32 v[60:61], v[60:61], v[68:69]
    v_pk_mul_f32 v[62:63], v[62:63], v[70:71]
    ds_read_u16 v3, v6 offset:1030
    v_cvt_pk_bf16_f32 v64, v56, v57
    v_cvt_pk_bf16_f32 v65, v58, v59
    v_cvt_pk_bf16_f32 v66, v60, v61
    v_cvt_pk_bf16_f32 v67, v62, v63
    v_exp_f32_e64 v56, v72
    v_exp_f32 v57, v73
    s_waitcnt lgkmcnt(1)
    v_mfma_f32_32x32x16_bf16 v[96:111], v[64:67], v[32:35], v[96:111]
    v_exp_f32 v58, v74
    v_exp_f32 v59, v75
    v_exp_f32 v60, v76
    v_exp_f32 v61, v77
    v_exp_f32 v62, v78
    v_exp_f32 v63, v79
    v_pk_add_f32 v[56:57], v[56:57], 1.0 op_sel_hi:[1,0]
    v_pk_add_f32 v[58:59], v[58:59], 1.0 op_sel_hi:[1,0]
    v_pk_add_f32 v[60:61], v[60:61], 1.0 op_sel_hi:[1,0]
    v_pk_add_f32 v[62:63], v[62:63], 1.0 op_sel_hi:[1,0]
    v_pk_add_f32 v[38:39], v[38:39], v[8:9] op_sel_hi:[1,0]
    ds_read_b64_tr_b16 v[36:37], v38 offset:776
    ds_read_b64_tr_b16 v[38:39], v39 offset:904
    s_waitcnt lgkmcnt(2)
    s_mov_b32 exec_lo, 0
    ds_read_b128 v[20:23], v3
    s_not_b64 exec, exec
    ds_read_b32 v20, v6 offset:1024
    s_mov_b64 exec, -1
    v_rcp_f32 v56, v56
    v_rcp_f32 v57, v57
    v_rcp_f32 v58, v58
    v_rcp_f32 v59, v59
    v_rcp_f32 v60, v60
    v_rcp_f32 v61, v61
    v_rcp_f32 v62, v62
    v_rcp_f32 v63, v63
    v_pk_mul_f32 v[56:57], v[56:57], v[72:73]
    v_pk_mul_f32 v[58:59], v[58:59], v[74:75]
    v_pk_mul_f32 v[60:61], v[60:61], v[76:77]
    v_pk_mul_f32 v[62:63], v[62:63], v[78:79]
    ds_read_u16 v12, v7 offset:1540
    ds_read_u16 v14, v7 offset:1668
    ds_read_u16 v16, v7 offset:1796
    ds_read_u16 v18, v7 offset:1924
    v_cvt_pk_bf16_f32 v72, v56, v57
    v_cvt_pk_bf16_f32 v73, v58, v59
    v_cvt_pk_bf16_f32 v74, v60, v61
    v_cvt_pk_bf16_f32 v75, v62, v63
    v_exp_f32_e64 v56, v80
    v_exp_f32 v57, v81
    s_waitcnt lgkmcnt(6)
    v_mfma_f32_32x32x16_bf16 v[96:111], v[72:75], v[36:39], v[96:111]
    v_exp_f32 v58, v82
    v_exp_f32 v59, v83
    v_exp_f32 v60, v84
    v_exp_f32 v61, v85
    v_exp_f32 v62, v86
    v_exp_f32 v63, v87
    v_pk_add_f32 v[56:57], v[56:57], 1.0 op_sel_hi:[1,0]
    v_pk_add_f32 v[58:59], v[58:59], 1.0 op_sel_hi:[1,0]
    v_pk_add_f32 v[60:61], v[60:61], 1.0 op_sel_hi:[1,0]
    v_pk_add_f32 v[62:63], v[62:63], 1.0 op_sel_hi:[1,0]
    v_rcp_f32 v56, v56
    v_rcp_f32 v57, v57
    v_rcp_f32 v58, v58
    v_rcp_f32 v59, v59
    v_rcp_f32 v60, v60
    v_rcp_f32 v61, v61
    v_rcp_f32 v62, v62
    v_rcp_f32 v63, v63
    v_pk_mul_f32 v[56:57], v[56:57], v[80:81]
    v_pk_mul_f32 v[58:59], v[58:59], v[82:83]
    v_pk_mul_f32 v[60:61], v[60:61], v[84:85]
    v_pk_mul_f32 v[62:63], v[62:63], v[86:87]
    s_waitcnt vmcnt(0)
    ds_read_b64_tr_b16 v[64:65], v4 offset:0
    ds_read_b64_tr_b16 v[66:67], v4 offset:256
    ds_read_b64_tr_b16 v[68:69], v4 offset:1024
    ds_read_b64_tr_b16 v[70:71], v4 offset:1280
    ds_read_b64_tr_b16 v[72:73], v4 offset:2048
    ds_read_b64_tr_b16 v[74:75], v4 offset:2304
    ds_read_b64_tr_b16 v[76:77], v4 offset:3072
    ds_read_b64_tr_b16 v[78:79], v4 offset:3328
    v_cvt_pk_bf16_f32 v80, v56, v57
    v_cvt_pk_bf16_f32 v81, v58, v59
    v_cvt_pk_bf16_f32 v82, v60, v61
    v_cvt_pk_bf16_f32 v83, v62, v63
    v_exp_f32 v56, v88
    v_exp_f32_e64 v57, v89
    v_mfma_f32_32x32x16_bf16 v[112:127], v[80:83], v[32:35], v[112:127]
    v_exp_f32 v58, v90
    v_exp_f32 v59, v91
    v_exp_f32 v60, v92
    v_exp_f32 v61, v93
    v_exp_f32 v62, v94
    v_exp_f32 v63, v95
    v_pk_add_f32 v[56:57], v[56:57], 1.0 op_sel_hi:[1,0]
    v_pk_add_f32 v[58:59], v[58:59], 1.0 op_sel_hi:[1,0]
    v_pk_add_f32 v[60:61], v[60:61], 1.0 op_sel_hi:[1,0]
    v_pk_add_f32 v[62:63], v[62:63], 1.0 op_sel_hi:[1,0]
    ds_read_b64_tr_b16 v[40:41], v4 offset:64
    ds_read_b64_tr_b16 v[42:43], v4 offset:320
    ds_read_b64_tr_b16 v[44:45], v4 offset:1088
    ds_read_b64_tr_b16 v[46:47], v4 offset:1344
    ds_read_b64_tr_b16 v[48:49], v4 offset:2112
    ds_read_b64_tr_b16 v[50:51], v4 offset:2368
    ds_read_b64_tr_b16 v[52:53], v4 offset:3136
    ds_read_b64_tr_b16 v[54:55], v4 offset:3392
    s_waitcnt lgkmcnt(8)
    v_mfma_f32_32x32x16_bf16 v[64:79], v[20:23], v[24:27], v[64:79]
    v_rcp_f32 v56, v56
    v_rcp_f32 v57, v57
    v_rcp_f32 v58, v58
    v_rcp_f32 v59, v59
    v_rcp_f32 v60, v60
    v_rcp_f32 v61, v61
    v_rcp_f32 v62, v62
    v_rcp_f32_e64 v63, v63
    v_pk_mul_f32 v[56:57], v[56:57], v[88:89]
    v_pk_mul_f32 v[58:59], v[58:59], v[90:91]
    v_pk_mul_f32 v[60:61], v[60:61], v[92:93]
    v_pk_mul_f32 v[62:63], v[62:63], v[94:95]
    ds_read_u16_d16_hi v34, v9 offset:1030
    ds_read_u16_d16_hi v35, v9 offset:1158
    s_waitcnt lgkmcnt(2)
    buffer_load_dwordx4 v[12:13], s[48:51], 0 idxen offen offset:0 sc1 lds
    buffer_load_dwordx4 v[14:15], s[48:51], 0 idxen offen offset:1024 sc1 lds
    buffer_load_dwordx4 v[16:17], s[48:51], 0 idxen offen offset:2048 sc1 lds
    buffer_load_dwordx4 v[18:19], s[48:51], 0 idxen offen offset:3072 sc1 lds
    v_cvt_pk_bf16_f32 v88, v56, v57
    v_cvt_pk_bf16_f32 v89, v58, v59
    v_cvt_pk_bf16_f32 v90, v60, v61
    v_cvt_pk_bf16_f32 v91, v62, v63
L_u2:
    v_exp_f32 v56, v64
    v_exp_f32 v57, v65
    s_waitcnt lgkmcnt(0)
    v_mfma_f32_32x32x16_bf16 v[112:127], v[88:91], v[36:39], v[112:127]
    v_exp_f32 v58, v66
    v_exp_f32 v59, v67
    v_exp_f32 v60, v68
    v_exp_f32 v61, v69
    v_exp_f32 v62, v70
    v_exp_f32 v63, v71
    v_pk_add_f32 v[56:57], v[56:57], 1.0 op_sel_hi:[1,0]
    v_pk_add_f32 v[58:59], v[58:59], 1.0 op_sel_hi:[1,0]
    v_pk_add_f32 v[60:61], v[60:61], 1.0 op_sel_hi:[1,0]
    v_pk_add_f32 v[62:63], v[62:63], 1.0 op_sel_hi:[1,0]
    v_pk_add_f32 v[34:35], v[34:35], v[8:9] op_sel_hi:[1,0]
    ds_read_u16_d16_hi v38, v9 offset:1286
    ds_read_u16_d16_hi v39, v9 offset:1414
    ds_read_b64_tr_b16 v[32:33], v34 offset:1032
    ds_read_b64_tr_b16 v[34:35], v35 offset:1160
    v_mfma_f32_32x32x16_bf16 v[80:95], v[20:23], v[28:31], v[40:55]
    v_rcp_f32 v56, v56
    v_rcp_f32 v57, v57
    v_rcp_f32 v58, v58
    v_rcp_f32 v59, v59
    v_rcp_f32 v60, v60
    v_rcp_f32 v61, v61
    v_rcp_f32 v62, v62
    v_rcp_f32 v63, v63
    v_pk_mul_f32 v[56:57], v[56:57], v[64:65]
    v_pk_mul_f32 v[58:59], v[58:59], v[66:67]
    v_pk_mul_f32 v[60:61], v[60:61], v[68:69]
    v_pk_mul_f32 v[62:63], v[62:63], v[70:71]
    ds_read_u16 v3, v6 offset:1542
    v_cvt_pk_bf16_f32 v64, v56, v57
    v_cvt_pk_bf16_f32 v65, v58, v59
    v_cvt_pk_bf16_f32 v66, v60, v61
    v_cvt_pk_bf16_f32 v67, v62, v63
    v_exp_f32_e64 v56, v72
    v_exp_f32 v57, v73
    s_waitcnt lgkmcnt(1)
    v_mfma_f32_32x32x16_bf16 v[96:111], v[64:67], v[32:35], v[96:111]
    v_exp_f32 v58, v74
    v_exp_f32 v59, v75
    v_exp_f32 v60, v76
    v_exp_f32 v61, v77
    v_exp_f32 v62, v78
    v_exp_f32 v63, v79
    v_pk_add_f32 v[56:57], v[56:57], 1.0 op_sel_hi:[1,0]
    v_pk_add_f32 v[58:59], v[58:59], 1.0 op_sel_hi:[1,0]
    v_pk_add_f32 v[60:61], v[60:61], 1.0 op_sel_hi:[1,0]
    v_pk_add_f32 v[62:63], v[62:63], 1.0 op_sel_hi:[1,0]
    v_pk_add_f32 v[38:39], v[38:39], v[8:9] op_sel_hi:[1,0]
    ds_read_b64_tr_b16 v[36:37], v38 offset:1288
    ds_read_b64_tr_b16 v[38:39], v39 offset:1416
    s_waitcnt lgkmcnt(2)
    s_mov_b32 exec_lo, 0
    ds_read_b128 v[20:23], v3
    s_not_b64 exec, exec
    ds_read_b32 v20, v6 offset:1536
    s_mov_b64 exec, -1
    v_rcp_f32 v56, v56
    v_rcp_f32 v57, v57
    v_rcp_f32 v58, v58
    v_rcp_f32 v59, v59
    v_rcp_f32 v60, v60
    v_rcp_f32 v61, v61
    v_rcp_f32 v62, v62
    v_rcp_f32 v63, v63
    v_pk_mul_f32 v[56:57], v[56:57], v[72:73]
    v_pk_mul_f32 v[58:59], v[58:59], v[74:75]
    v_pk_mul_f32 v[60:61], v[60:61], v[76:77]
    v_pk_mul_f32 v[62:63], v[62:63], v[78:79]
    ds_read_u16 v12, v7 offset:2052
    ds_read_u16 v14, v7 offset:2180
    ds_read_u16 v16, v7 offset:2308
    ds_read_u16 v18, v7 offset:2436
    v_cvt_pk_bf16_f32 v72, v56, v57
    v_cvt_pk_bf16_f32 v73, v58, v59
    v_cvt_pk_bf16_f32 v74, v60, v61
    v_cvt_pk_bf16_f32 v75, v62, v63
    v_exp_f32_e64 v56, v80
    v_exp_f32 v57, v81
    s_waitcnt lgkmcnt(6)
    v_mfma_f32_32x32x16_bf16 v[96:111], v[72:75], v[36:39], v[96:111]
    v_exp_f32 v58, v82
    v_exp_f32 v59, v83
    v_exp_f32 v60, v84
    v_exp_f32 v61, v85
    v_exp_f32 v62, v86
    v_exp_f32 v63, v87
    v_pk_add_f32 v[56:57], v[56:57], 1.0 op_sel_hi:[1,0]
    v_pk_add_f32 v[58:59], v[58:59], 1.0 op_sel_hi:[1,0]
    v_pk_add_f32 v[60:61], v[60:61], 1.0 op_sel_hi:[1,0]
    v_pk_add_f32 v[62:63], v[62:63], 1.0 op_sel_hi:[1,0]
    v_rcp_f32 v56, v56
    v_rcp_f32 v57, v57
    v_rcp_f32 v58, v58
    v_rcp_f32 v59, v59
    v_rcp_f32 v60, v60
    v_rcp_f32 v61, v61
    v_rcp_f32 v62, v62
    v_rcp_f32 v63, v63
    v_pk_mul_f32 v[56:57], v[56:57], v[80:81]
    v_pk_mul_f32 v[58:59], v[58:59], v[82:83]
    v_pk_mul_f32 v[60:61], v[60:61], v[84:85]
    v_pk_mul_f32 v[62:63], v[62:63], v[86:87]
    s_waitcnt vmcnt(0)
    ds_read_b64_tr_b16 v[64:65], v4 offset:0
    ds_read_b64_tr_b16 v[66:67], v4 offset:256
    ds_read_b64_tr_b16 v[68:69], v4 offset:1024
    ds_read_b64_tr_b16 v[70:71], v4 offset:1280
    ds_read_b64_tr_b16 v[72:73], v4 offset:2048
    ds_read_b64_tr_b16 v[74:75], v4 offset:2304
    ds_read_b64_tr_b16 v[76:77], v4 offset:3072
    ds_read_b64_tr_b16 v[78:79], v4 offset:3328
    v_cvt_pk_bf16_f32 v80, v56, v57
    v_cvt_pk_bf16_f32 v81, v58, v59
    v_cvt_pk_bf16_f32 v82, v60, v61
    v_cvt_pk_bf16_f32 v83, v62, v63
    v_exp_f32 v56, v88
    v_exp_f32_e64 v57, v89
    v_mfma_f32_32x32x16_bf16 v[112:127], v[80:83], v[32:35], v[112:127]
    v_exp_f32 v58, v90
    v_exp_f32 v59, v91
    v_exp_f32 v60, v92
    v_exp_f32 v61, v93
    v_exp_f32 v62, v94
    v_exp_f32 v63, v95
    v_pk_add_f32 v[56:57], v[56:57], 1.0 op_sel_hi:[1,0]
    v_pk_add_f32 v[58:59], v[58:59], 1.0 op_sel_hi:[1,0]
    v_pk_add_f32 v[60:61], v[60:61], 1.0 op_sel_hi:[1,0]
    v_pk_add_f32 v[62:63], v[62:63], 1.0 op_sel_hi:[1,0]
    ds_read_b64_tr_b16 v[40:41], v4 offset:64
    ds_read_b64_tr_b16 v[42:43], v4 offset:320
    ds_read_b64_tr_b16 v[44:45], v4 offset:1088
    ds_read_b64_tr_b16 v[46:47], v4 offset:1344
    ds_read_b64_tr_b16 v[48:49], v4 offset:2112
    ds_read_b64_tr_b16 v[50:51], v4 offset:2368
    ds_read_b64_tr_b16 v[52:53], v4 offset:3136
    ds_read_b64_tr_b16 v[54:55], v4 offset:3392
    s_waitcnt lgkmcnt(8)
    v_mfma_f32_32x32x16_bf16 v[64:79], v[20:23], v[24:27], v[64:79]
    v_rcp_f32 v56, v56
    v_rcp_f32 v57, v57
    v_rcp_f32 v58, v58
    v_rcp_f32 v59, v59
    v_rcp_f32 v60, v60
    v_rcp_f32 v61, v61
    v_rcp_f32 v62, v62
    v_rcp_f32_e64 v63, v63
    v_pk_mul_f32 v[56:57], v[56:57], v[88:89]
    v_pk_mul_f32 v[58:59], v[58:59], v[90:91]
    v_pk_mul_f32 v[60:61], v[60:61], v[92:93]
    v_pk_mul_f32 v[62:63], v[62:63], v[94:95]
    ds_read_u16_d16_hi v34, v9 offset:1542
    ds_read_u16_d16_hi v35, v9 offset:1670
    s_waitcnt lgkmcnt(2)
    buffer_load_dwordx4 v[12:13], s[48:51], 0 idxen offen offset:0 sc1 lds
    buffer_load_dwordx4 v[14:15], s[48:51], 0 idxen offen offset:1024 sc1 lds
    buffer_load_dwordx4 v[16:17], s[48:51], 0 idxen offen offset:2048 sc1 lds
    buffer_load_dwordx4 v[18:19], s[48:51], 0 idxen offen offset:3072 sc1 lds
    v_cvt_pk_bf16_f32 v88, v56, v57
    v_cvt_pk_bf16_f32 v89, v58, v59
    v_cvt_pk_bf16_f32 v90, v60, v61
    v_cvt_pk_bf16_f32 v91, v62, v63
L_u3:
    v_exp_f32 v56, v64
    v_exp_f32 v57, v65
    s_waitcnt lgkmcnt(0)
    v_mfma_f32_32x32x16_bf16 v[112:127], v[88:91], v[36:39], v[112:127]
    v_exp_f32 v58, v66
    v_exp_f32 v59, v67
    v_exp_f32 v60, v68
    v_exp_f32 v61, v69
    v_exp_f32 v62, v70
    v_exp_f32 v63, v71
    v_pk_add_f32 v[56:57], v[56:57], 1.0 op_sel_hi:[1,0]
    v_pk_add_f32 v[58:59], v[58:59], 1.0 op_sel_hi:[1,0]
    v_pk_add_f32 v[60:61], v[60:61], 1.0 op_sel_hi:[1,0]
    v_pk_add_f32 v[62:63], v[62:63], 1.0 op_sel_hi:[1,0]
    v_pk_add_f32 v[34:35], v[34:35], v[8:9] op_sel_hi:[1,0]
    ds_read_u16_d16_hi v38, v9 offset:1798
    ds_read_u16_d16_hi v39, v9 offset:1926
    ds_read_b64_tr_b16 v[32:33], v34 offset:1544
    ds_read_b64_tr_b16 v[34:35], v35 offset:1672
    v_mfma_f32_32x32x16_bf16 v[80:95], v[20:23], v[28:31], v[40:55]
    v_rcp_f32 v56, v56
    v_rcp_f32 v57, v57
    v_rcp_f32 v58, v58
    v_rcp_f32 v59, v59
    v_rcp_f32 v60, v60
    v_rcp_f32 v61, v61
    v_rcp_f32 v62, v62
    v_rcp_f32 v63, v63
    v_pk_mul_f32 v[56:57], v[56:57], v[64:65]
    v_pk_mul_f32 v[58:59], v[58:59], v[66:67]
    v_pk_mul_f32 v[60:61], v[60:61], v[68:69]
    v_pk_mul_f32 v[62:63], v[62:63], v[70:71]
    ds_read_u16 v3, v6 offset:2054
    v_cvt_pk_bf16_f32 v64, v56, v57
    v_cvt_pk_bf16_f32 v65, v58, v59
    v_cvt_pk_bf16_f32 v66, v60, v61
    v_cvt_pk_bf16_f32 v67, v62, v63
    v_exp_f32_e64 v56, v72
    v_exp_f32 v57, v73
    s_waitcnt lgkmcnt(1)
    v_mfma_f32_32x32x16_bf16 v[96:111], v[64:67], v[32:35], v[96:111]
    v_exp_f32 v58, v74
    v_exp_f32 v59, v75
    v_exp_f32 v60, v76
    v_exp_f32 v61, v77
    v_exp_f32 v62, v78
    v_exp_f32 v63, v79
    v_pk_add_f32 v[56:57], v[56:57], 1.0 op_sel_hi:[1,0]
    v_pk_add_f32 v[58:59], v[58:59], 1.0 op_sel_hi:[1,0]
    v_pk_add_f32 v[60:61], v[60:61], 1.0 op_sel_hi:[1,0]
    v_pk_add_f32 v[62:63], v[62:63], 1.0 op_sel_hi:[1,0]
    v_pk_add_f32 v[38:39], v[38:39], v[8:9] op_sel_hi:[1,0]
    ds_read_b64_tr_b16 v[36:37], v38 offset:1800
    ds_read_b64_tr_b16 v[38:39], v39 offset:1928
    s_waitcnt lgkmcnt(2)
    s_mov_b32 exec_lo, 0
    ds_read_b128 v[20:23], v3
    s_not_b64 exec, exec
    ds_read_b32 v20, v6 offset:2048
    s_mov_b64 exec, -1
    v_rcp_f32 v56, v56
    v_rcp_f32 v57, v57
    v_rcp_f32 v58, v58
    v_rcp_f32 v59, v59
    v_rcp_f32 v60, v60
    v_rcp_f32 v61, v61
    v_rcp_f32 v62, v62
    v_rcp_f32 v63, v63
    v_pk_mul_f32 v[56:57], v[56:57], v[72:73]
    v_pk_mul_f32 v[58:59], v[58:59], v[74:75]
    v_pk_mul_f32 v[60:61], v[60:61], v[76:77]
    v_pk_mul_f32 v[62:63], v[62:63], v[78:79]
    ds_read_u16 v12, v7 offset:2564
    ds_read_u16 v14, v7 offset:2692
    ds_read_u16 v16, v7 offset:2820
    ds_read_u16 v18, v7 offset:2948
    v_cvt_pk_bf16_f32 v72, v56, v57
    v_cvt_pk_bf16_f32 v73, v58, v59
    v_cvt_pk_bf16_f32 v74, v60, v61
    v_cvt_pk_bf16_f32 v75, v62, v63
    v_exp_f32_e64 v56, v80
    v_exp_f32 v57, v81
    s_waitcnt lgkmcnt(6)
    v_mfma_f32_32x32x16_bf16 v[96:111], v[72:75], v[36:39], v[96:111]
    v_exp_f32 v58, v82
    v_exp_f32 v59, v83
    v_exp_f32 v60, v84
    v_exp_f32 v61, v85
    v_exp_f32 v62, v86
    v_exp_f32 v63, v87
    v_pk_add_f32 v[56:57], v[56:57], 1.0 op_sel_hi:[1,0]
    v_pk_add_f32 v[58:59], v[58:59], 1.0 op_sel_hi:[1,0]
    v_pk_add_f32 v[60:61], v[60:61], 1.0 op_sel_hi:[1,0]
    v_pk_add_f32 v[62:63], v[62:63], 1.0 op_sel_hi:[1,0]
    v_rcp_f32 v56, v56
    v_rcp_f32 v57, v57
    v_rcp_f32 v58, v58
    v_rcp_f32 v59, v59
    v_rcp_f32 v60, v60
    v_rcp_f32 v61, v61
    v_rcp_f32 v62, v62
    v_rcp_f32 v63, v63
    v_pk_mul_f32 v[56:57], v[56:57], v[80:81]
    v_pk_mul_f32 v[58:59], v[58:59], v[82:83]
    v_pk_mul_f32 v[60:61], v[60:61], v[84:85]
    v_pk_mul_f32 v[62:63], v[62:63], v[86:87]
    s_waitcnt vmcnt(0)
    ds_read_b64_tr_b16 v[64:65], v4 offset:0
    ds_read_b64_tr_b16 v[66:67], v4 offset:256
    ds_read_b64_tr_b16 v[68:69], v4 offset:1024
    ds_read_b64_tr_b16 v[70:71], v4 offset:1280
    ds_read_b64_tr_b16 v[72:73], v4 offset:2048
    ds_read_b64_tr_b16 v[74:75], v4 offset:2304
    ds_read_b64_tr_b16 v[76:77], v4 offset:3072
    ds_read_b64_tr_b16 v[78:79], v4 offset:3328
    v_cvt_pk_bf16_f32 v80, v56, v57
    v_cvt_pk_bf16_f32 v81, v58, v59
    v_cvt_pk_bf16_f32 v82, v60, v61
    v_cvt_pk_bf16_f32 v83, v62, v63
    v_exp_f32 v56, v88
    v_exp_f32_e64 v57, v89
    v_mfma_f32_32x32x16_bf16 v[112:127], v[80:83], v[32:35], v[112:127]
    v_exp_f32 v58, v90
    v_exp_f32 v59, v91
    v_exp_f32 v60, v92
    v_exp_f32 v61, v93
    v_exp_f32 v62, v94
    v_exp_f32 v63, v95
    v_pk_add_f32 v[56:57], v[56:57], 1.0 op_sel_hi:[1,0]
    v_pk_add_f32 v[58:59], v[58:59], 1.0 op_sel_hi:[1,0]
    v_pk_add_f32 v[60:61], v[60:61], 1.0 op_sel_hi:[1,0]
    v_pk_add_f32 v[62:63], v[62:63], 1.0 op_sel_hi:[1,0]
    ds_read_b64_tr_b16 v[40:41], v4 offset:64
    ds_read_b64_tr_b16 v[42:43], v4 offset:320
    ds_read_b64_tr_b16 v[44:45], v4 offset:1088
    ds_read_b64_tr_b16 v[46:47], v4 offset:1344
    ds_read_b64_tr_b16 v[48:49], v4 offset:2112
    ds_read_b64_tr_b16 v[50:51], v4 offset:2368
    ds_read_b64_tr_b16 v[52:53], v4 offset:3136
    ds_read_b64_tr_b16 v[54:55], v4 offset:3392
    s_waitcnt lgkmcnt(8)
    v_mfma_f32_32x32x16_bf16 v[64:79], v[20:23], v[24:27], v[64:79]
    v_rcp_f32 v56, v56
    v_rcp_f32 v57, v57
    v_rcp_f32 v58, v58
    v_rcp_f32 v59, v59
    v_rcp_f32 v60, v60
    v_rcp_f32 v61, v61
    v_rcp_f32 v62, v62
    v_rcp_f32_e64 v63, v63
    v_pk_mul_f32 v[56:57], v[56:57], v[88:89]
    v_pk_mul_f32 v[58:59], v[58:59], v[90:91]
    v_pk_mul_f32 v[60:61], v[60:61], v[92:93]
    v_pk_mul_f32 v[62:63], v[62:63], v[94:95]
    ds_read_u16_d16_hi v34, v9 offset:2054
    ds_read_u16_d16_hi v35, v9 offset:2182
    s_waitcnt lgkmcnt(2)
    buffer_load_dwordx4 v[12:13], s[48:51], 0 idxen offen offset:0 sc1 lds
    buffer_load_dwordx4 v[14:15], s[48:51], 0 idxen offen offset:1024 sc1 lds
    buffer_load_dwordx4 v[16:17], s[48:51], 0 idxen offen offset:2048 sc1 lds
    buffer_load_dwordx4 v[18:19], s[48:51], 0 idxen offen offset:3072 sc1 lds
    v_cvt_pk_bf16_f32 v88, v56, v57
    v_cvt_pk_bf16_f32 v89, v58, v59
    v_cvt_pk_bf16_f32 v90, v60, v61
    v_cvt_pk_bf16_f32 v91, v62, v63
L_u4:
    v_exp_f32 v56, v64
    v_exp_f32 v57, v65
    s_waitcnt lgkmcnt(0)
    v_mfma_f32_32x32x16_bf16 v[112:127], v[88:91], v[36:39], v[112:127]
    v_exp_f32 v58, v66
    v_exp_f32 v59, v67
    v_exp_f32 v60, v68
    v_exp_f32 v61, v69
    v_exp_f32 v62, v70
    v_exp_f32 v63, v71
    v_pk_add_f32 v[56:57], v[56:57], 1.0 op_sel_hi:[1,0]
    v_pk_add_f32 v[58:59], v[58:59], 1.0 op_sel_hi:[1,0]
    v_pk_add_f32 v[60:61], v[60:61], 1.0 op_sel_hi:[1,0]
    v_pk_add_f32 v[62:63], v[62:63], 1.0 op_sel_hi:[1,0]
    v_pk_add_f32 v[34:35], v[34:35], v[8:9] op_sel_hi:[1,0]
    ds_read_u16_d16_hi v38, v9 offset:2310
    ds_read_u16_d16_hi v39, v9 offset:2438
    ds_read_b64_tr_b16 v[32:33], v34 offset:2056
    ds_read_b64_tr_b16 v[34:35], v35 offset:2184
    v_mfma_f32_32x32x16_bf16 v[80:95], v[20:23], v[28:31], v[40:55]
    v_rcp_f32 v56, v56
    v_rcp_f32 v57, v57
    v_rcp_f32 v58, v58
    v_rcp_f32 v59, v59
    v_rcp_f32 v60, v60
    v_rcp_f32 v61, v61
    v_rcp_f32 v62, v62
    v_rcp_f32 v63, v63
    v_pk_mul_f32 v[56:57], v[56:57], v[64:65]
    v_pk_mul_f32 v[58:59], v[58:59], v[66:67]
    v_pk_mul_f32 v[60:61], v[60:61], v[68:69]
    v_pk_mul_f32 v[62:63], v[62:63], v[70:71]
    ds_read_u16 v3, v6 offset:2566
    v_cvt_pk_bf16_f32 v64, v56, v57
    v_cvt_pk_bf16_f32 v65, v58, v59
    v_cvt_pk_bf16_f32 v66, v60, v61
    v_cvt_pk_bf16_f32 v67, v62, v63
    v_exp_f32_e64 v56, v72
    v_exp_f32 v57, v73
    s_waitcnt lgkmcnt(1)
    v_mfma_f32_32x32x16_bf16 v[96:111], v[64:67], v[32:35], v[96:111]
    v_exp_f32 v58, v74
    v_exp_f32 v59, v75
    v_exp_f32 v60, v76
    v_exp_f32 v61, v77
    v_exp_f32 v62, v78
    v_exp_f32 v63, v79
    v_pk_add_f32 v[56:57], v[56:57], 1.0 op_sel_hi:[1,0]
    v_pk_add_f32 v[58:59], v[58:59], 1.0 op_sel_hi:[1,0]
    v_pk_add_f32 v[60:61], v[60:61], 1.0 op_sel_hi:[1,0]
    v_pk_add_f32 v[62:63], v[62:63], 1.0 op_sel_hi:[1,0]
    v_pk_add_f32 v[38:39], v[38:39], v[8:9] op_sel_hi:[1,0]
    ds_read_b64_tr_b16 v[36:37], v38 offset:2312
    ds_read_b64_tr_b16 v[38:39], v39 offset:2440
    s_waitcnt lgkmcnt(2)
    s_mov_b32 exec_lo, 0
    ds_read_b128 v[20:23], v3
    s_not_b64 exec, exec
    ds_read_b32 v20, v6 offset:2560
    s_mov_b64 exec, -1
    v_rcp_f32 v56, v56
    v_rcp_f32 v57, v57
    v_rcp_f32 v58, v58
    v_rcp_f32 v59, v59
    v_rcp_f32 v60, v60
    v_rcp_f32 v61, v61
    v_rcp_f32 v62, v62
    v_rcp_f32 v63, v63
    v_pk_mul_f32 v[56:57], v[56:57], v[72:73]
    v_pk_mul_f32 v[58:59], v[58:59], v[74:75]
    v_pk_mul_f32 v[60:61], v[60:61], v[76:77]
    v_pk_mul_f32 v[62:63], v[62:63], v[78:79]
    ds_read_u16 v12, v7 offset:3076
    ds_read_u16 v14, v7 offset:3204
    ds_read_u16 v16, v7 offset:3332
    ds_read_u16 v18, v7 offset:3460
    v_cvt_pk_bf16_f32 v72, v56, v57
    v_cvt_pk_bf16_f32 v73, v58, v59
    v_cvt_pk_bf16_f32 v74, v60, v61
    v_cvt_pk_bf16_f32 v75, v62, v63
    v_exp_f32_e64 v56, v80
    v_exp_f32 v57, v81
    s_waitcnt lgkmcnt(6)
    v_mfma_f32_32x32x16_bf16 v[96:111], v[72:75], v[36:39], v[96:111]
    v_exp_f32 v58, v82
    v_exp_f32 v59, v83
    v_exp_f32 v60, v84
    v_exp_f32 v61, v85
    v_exp_f32 v62, v86
    v_exp_f32 v63, v87
    v_pk_add_f32 v[56:57], v[56:57], 1.0 op_sel_hi:[1,0]
    v_pk_add_f32 v[58:59], v[58:59], 1.0 op_sel_hi:[1,0]
    v_pk_add_f32 v[60:61], v[60:61], 1.0 op_sel_hi:[1,0]
    v_pk_add_f32 v[62:63], v[62:63], 1.0 op_sel_hi:[1,0]
    v_rcp_f32 v56, v56
    v_rcp_f32 v57, v57
    v_rcp_f32 v58, v58
    v_rcp_f32 v59, v59
    v_rcp_f32 v60, v60
    v_rcp_f32 v61, v61
    v_rcp_f32 v62, v62
    v_rcp_f32 v63, v63
    v_pk_mul_f32 v[56:57], v[56:57], v[80:81]
    v_pk_mul_f32 v[58:59], v[58:59], v[82:83]
    v_pk_mul_f32 v[60:61], v[60:61], v[84:85]
    v_pk_mul_f32 v[62:63], v[62:63], v[86:87]
    s_waitcnt vmcnt(0)
    ds_read_b64_tr_b16 v[64:65], v4 offset:0
    ds_read_b64_tr_b16 v[66:67], v4 offset:256
    ds_read_b64_tr_b16 v[68:69], v4 offset:1024
    ds_read_b64_tr_b16 v[70:71], v4 offset:1280
    ds_read_b64_tr_b16 v[72:73], v4 offset:2048
    ds_read_b64_tr_b16 v[74:75], v4 offset:2304
    ds_read_b64_tr_b16 v[76:77], v4 offset:3072
    ds_read_b64_tr_b16 v[78:79], v4 offset:3328
    v_cvt_pk_bf16_f32 v80, v56, v57
    v_cvt_pk_bf16_f32 v81, v58, v59
    v_cvt_pk_bf16_f32 v82, v60, v61
    v_cvt_pk_bf16_f32 v83, v62, v63
    v_exp_f32 v56, v88
    v_exp_f32_e64 v57, v89
    v_mfma_f32_32x32x16_bf16 v[112:127], v[80:83], v[32:35], v[112:127]
    v_exp_f32 v58, v90
    v_exp_f32 v59, v91
    v_exp_f32 v60, v92
    v_exp_f32 v61, v93
    v_exp_f32 v62, v94
    v_exp_f32 v63, v95
    v_pk_add_f32 v[56:57], v[56:57], 1.0 op_sel_hi:[1,0]
    v_pk_add_f32 v[58:59], v[58:59], 1.0 op_sel_hi:[1,0]
    v_pk_add_f32 v[60:61], v[60:61], 1.0 op_sel_hi:[1,0]
    v_pk_add_f32 v[62:63], v[62:63], 1.0 op_sel_hi:[1,0]
    ds_read_b64_tr_b16 v[40:41], v4 offset:64
    ds_read_b64_tr_b16 v[42:43], v4 offset:320
    ds_read_b64_tr_b16 v[44:45], v4 offset:1088
    ds_read_b64_tr_b16 v[46:47], v4 offset:1344
    ds_read_b64_tr_b16 v[48:49], v4 offset:2112
    ds_read_b64_tr_b16 v[50:51], v4 offset:2368
    ds_read_b64_tr_b16 v[52:53], v4 offset:3136
    ds_read_b64_tr_b16 v[54:55], v4 offset:3392
    s_waitcnt lgkmcnt(8)
    v_mfma_f32_32x32x16_bf16 v[64:79], v[20:23], v[24:27], v[64:79]
    v_rcp_f32 v56, v56
    v_rcp_f32 v57, v57
    v_rcp_f32 v58, v58
    v_rcp_f32 v59, v59
    v_rcp_f32 v60, v60
    v_rcp_f32 v61, v61
    v_rcp_f32 v62, v62
    v_rcp_f32_e64 v63, v63
    v_pk_mul_f32 v[56:57], v[56:57], v[88:89]
    v_pk_mul_f32 v[58:59], v[58:59], v[90:91]
    v_pk_mul_f32 v[60:61], v[60:61], v[92:93]
    v_pk_mul_f32 v[62:63], v[62:63], v[94:95]
    ds_read_u16_d16_hi v34, v9 offset:2566
    ds_read_u16_d16_hi v35, v9 offset:2694
    s_waitcnt lgkmcnt(2)
    buffer_load_dwordx4 v[12:13], s[48:51], 0 idxen offen offset:0 sc1 lds
    buffer_load_dwordx4 v[14:15], s[48:51], 0 idxen offen offset:1024 sc1 lds
    buffer_load_dwordx4 v[16:17], s[48:51], 0 idxen offen offset:2048 sc1 lds
    buffer_load_dwordx4 v[18:19], s[48:51], 0 idxen offen offset:3072 sc1 lds
    v_cvt_pk_bf16_f32 v88, v56, v57
    v_cvt_pk_bf16_f32 v89, v58, v59
    v_cvt_pk_bf16_f32 v90, v60, v61
    v_cvt_pk_bf16_f32 v91, v62, v63
L_u5:
    v_exp_f32 v56, v64
    v_exp_f32 v57, v65
    s_waitcnt lgkmcnt(0)
    v_mfma_f32_32x32x16_bf16 v[112:127], v[88:91], v[36:39], v[112:127]
    v_exp_f32 v58, v66
    v_exp_f32 v59, v67
    v_exp_f32 v60, v68
    v_exp_f32 v61, v69
    v_exp_f32 v62, v70
    v_exp_f32 v63, v71
    v_pk_add_f32 v[56:57], v[56:57], 1.0 op_sel_hi:[1,0]
    v_pk_add_f32 v[58:59], v[58:59], 1.0 op_sel_hi:[1,0]
    v_pk_add_f32 v[60:61], v[60:61], 1.0 op_sel_hi:[1,0]
    v_pk_add_f32 v[62:63], v[62:63], 1.0 op_sel_hi:[1,0]
    v_pk_add_f32 v[34:35], v[34:35], v[8:9] op_sel_hi:[1,0]
    ds_read_u16_d16_hi v38, v9 offset:2822
    ds_read_u16_d16_hi v39, v9 offset:2950
    ds_read_b64_tr_b16 v[32:33], v34 offset:2568
    ds_read_b64_tr_b16 v[34:35], v35 offset:2696
    v_mfma_f32_32x32x16_bf16 v[80:95], v[20:23], v[28:31], v[40:55]
    v_rcp_f32 v56, v56
    v_rcp_f32 v57, v57
    v_rcp_f32 v58, v58
    v_rcp_f32 v59, v59
    v_rcp_f32 v60, v60
    v_rcp_f32 v61, v61
    v_rcp_f32 v62, v62
    v_rcp_f32 v63, v63
    v_pk_mul_f32 v[56:57], v[56:57], v[64:65]
    v_pk_mul_f32 v[58:59], v[58:59], v[66:67]
    v_pk_mul_f32 v[60:61], v[60:61], v[68:69]
    v_pk_mul_f32 v[62:63], v[62:63], v[70:71]
    ds_read_u16 v3, v6 offset:3078
    v_cvt_pk_bf16_f32 v64, v56, v57
    v_cvt_pk_bf16_f32 v65, v58, v59
    v_cvt_pk_bf16_f32 v66, v60, v61
    v_cvt_pk_bf16_f32 v67, v62, v63
    v_exp_f32_e64 v56, v72
    v_exp_f32 v57, v73
    s_waitcnt lgkmcnt(1)
    v_mfma_f32_32x32x16_bf16 v[96:111], v[64:67], v[32:35], v[96:111]
    v_exp_f32 v58, v74
    v_exp_f32 v59, v75
    v_exp_f32 v60, v76
    v_exp_f32 v61, v77
    v_exp_f32 v62, v78
    v_exp_f32 v63, v79
    v_pk_add_f32 v[56:57], v[56:57], 1.0 op_sel_hi:[1,0]
    v_pk_add_f32 v[58:59], v[58:59], 1.0 op_sel_hi:[1,0]
    v_pk_add_f32 v[60:61], v[60:61], 1.0 op_sel_hi:[1,0]
    v_pk_add_f32 v[62:63], v[62:63], 1.0 op_sel_hi:[1,0]
    v_pk_add_f32 v[38:39], v[38:39], v[8:9] op_sel_hi:[1,0]
    ds_read_b64_tr_b16 v[36:37], v38 offset:2824
    ds_read_b64_tr_b16 v[38:39], v39 offset:2952
    s_waitcnt lgkmcnt(2)
    s_mov_b32 exec_lo, 0
    ds_read_b128 v[20:23], v3
    s_not_b64 exec, exec
    ds_read_b32 v20, v6 offset:3072
    s_mov_b64 exec, -1
    v_rcp_f32 v56, v56
    v_rcp_f32 v57, v57
    v_rcp_f32 v58, v58
    v_rcp_f32 v59, v59
    v_rcp_f32 v60, v60
    v_rcp_f32 v61, v61
    v_rcp_f32 v62, v62
    v_rcp_f32 v63, v63
    v_pk_mul_f32 v[56:57], v[56:57], v[72:73]
    v_pk_mul_f32 v[58:59], v[58:59], v[74:75]
    v_pk_mul_f32 v[60:61], v[60:61], v[76:77]
    v_pk_mul_f32 v[62:63], v[62:63], v[78:79]
    ds_read_u16 v12, v7 offset:3588
    ds_read_u16 v14, v7 offset:3716
    ds_read_u16 v16, v7 offset:3844
    ds_read_u16 v18, v7 offset:3972
    v_cvt_pk_bf16_f32 v72, v56, v57
    v_cvt_pk_bf16_f32 v73, v58, v59
    v_cvt_pk_bf16_f32 v74, v60, v61
    v_cvt_pk_bf16_f32 v75, v62, v63
    v_exp_f32_e64 v56, v80
    v_exp_f32 v57, v81
    s_waitcnt lgkmcnt(6)
    v_mfma_f32_32x32x16_bf16 v[96:111], v[72:75], v[36:39], v[96:111]
    v_exp_f32 v58, v82
    v_exp_f32 v59, v83
    v_exp_f32 v60, v84
    v_exp_f32 v61, v85
    v_exp_f32 v62, v86
    v_exp_f32 v63, v87
    v_pk_add_f32 v[56:57], v[56:57], 1.0 op_sel_hi:[1,0]
    v_pk_add_f32 v[58:59], v[58:59], 1.0 op_sel_hi:[1,0]
    v_pk_add_f32 v[60:61], v[60:61], 1.0 op_sel_hi:[1,0]
    v_pk_add_f32 v[62:63], v[62:63], 1.0 op_sel_hi:[1,0]
    v_rcp_f32 v56, v56
    v_rcp_f32 v57, v57
    v_rcp_f32 v58, v58
    v_rcp_f32 v59, v59
    v_rcp_f32 v60, v60
    v_rcp_f32 v61, v61
    v_rcp_f32 v62, v62
    v_rcp_f32 v63, v63
    v_pk_mul_f32 v[56:57], v[56:57], v[80:81]
    v_pk_mul_f32 v[58:59], v[58:59], v[82:83]
    v_pk_mul_f32 v[60:61], v[60:61], v[84:85]
    v_pk_mul_f32 v[62:63], v[62:63], v[86:87]
    s_waitcnt vmcnt(0)
    ds_read_b64_tr_b16 v[64:65], v4 offset:0
    ds_read_b64_tr_b16 v[66:67], v4 offset:256
    ds_read_b64_tr_b16 v[68:69], v4 offset:1024
    ds_read_b64_tr_b16 v[70:71], v4 offset:1280
    ds_read_b64_tr_b16 v[72:73], v4 offset:2048
    ds_read_b64_tr_b16 v[74:75], v4 offset:2304
    ds_read_b64_tr_b16 v[76:77], v4 offset:3072
    ds_read_b64_tr_b16 v[78:79], v4 offset:3328
    v_cvt_pk_bf16_f32 v80, v56, v57
    v_cvt_pk_bf16_f32 v81, v58, v59
    v_cvt_pk_bf16_f32 v82, v60, v61
    v_cvt_pk_bf16_f32 v83, v62, v63
    v_exp_f32 v56, v88
    v_exp_f32_e64 v57, v89
    v_mfma_f32_32x32x16_bf16 v[112:127], v[80:83], v[32:35], v[112:127]
    v_exp_f32 v58, v90
    v_exp_f32 v59, v91
    v_exp_f32 v60, v92
    v_exp_f32 v61, v93
    v_exp_f32 v62, v94
    v_exp_f32 v63, v95
    v_pk_add_f32 v[56:57], v[56:57], 1.0 op_sel_hi:[1,0]
    v_pk_add_f32 v[58:59], v[58:59], 1.0 op_sel_hi:[1,0]
    v_pk_add_f32 v[60:61], v[60:61], 1.0 op_sel_hi:[1,0]
    v_pk_add_f32 v[62:63], v[62:63], 1.0 op_sel_hi:[1,0]
    ds_read_b64_tr_b16 v[40:41], v4 offset:64
    ds_read_b64_tr_b16 v[42:43], v4 offset:320
    ds_read_b64_tr_b16 v[44:45], v4 offset:1088
    ds_read_b64_tr_b16 v[46:47], v4 offset:1344
    ds_read_b64_tr_b16 v[48:49], v4 offset:2112
    ds_read_b64_tr_b16 v[50:51], v4 offset:2368
    ds_read_b64_tr_b16 v[52:53], v4 offset:3136
    ds_read_b64_tr_b16 v[54:55], v4 offset:3392
    s_waitcnt lgkmcnt(8)
    v_mfma_f32_32x32x16_bf16 v[64:79], v[20:23], v[24:27], v[64:79]
    v_rcp_f32 v56, v56
    v_rcp_f32 v57, v57
    v_rcp_f32 v58, v58
    v_rcp_f32 v59, v59
    v_rcp_f32 v60, v60
    v_rcp_f32 v61, v61
    v_rcp_f32 v62, v62
    v_rcp_f32_e64 v63, v63
    v_pk_mul_f32 v[56:57], v[56:57], v[88:89]
    v_pk_mul_f32 v[58:59], v[58:59], v[90:91]
    v_pk_mul_f32 v[60:61], v[60:61], v[92:93]
    v_pk_mul_f32 v[62:63], v[62:63], v[94:95]
    ds_read_u16_d16_hi v34, v9 offset:3078
    ds_read_u16_d16_hi v35, v9 offset:3206
    s_waitcnt lgkmcnt(2)
    buffer_load_dwordx4 v[12:13], s[48:51], 0 idxen offen offset:0 sc1 lds
    buffer_load_dwordx4 v[14:15], s[48:51], 0 idxen offen offset:1024 sc1 lds
    buffer_load_dwordx4 v[16:17], s[48:51], 0 idxen offen offset:2048 sc1 lds
    buffer_load_dwordx4 v[18:19], s[48:51], 0 idxen offen offset:3072 sc1 lds
    v_cvt_pk_bf16_f32 v88, v56, v57
    v_cvt_pk_bf16_f32 v89, v58, v59
    v_cvt_pk_bf16_f32 v90, v60, v61
    v_cvt_pk_bf16_f32 v91, v62, v63
L_u6:
    s_cmp_lt_u32 s63, 1
    s_cbranch_scc1 L_pr1
    s_setprio 2
L_pr1:
    v_exp_f32_e64 v56, v64
    v_exp_f32 v57, v65
    s_waitcnt lgkmcnt(0)
    v_mfma_f32_32x32x16_bf16 v[112:127], v[88:91], v[36:39], v[112:127]
    v_exp_f32 v58, v66
    v_exp_f32 v59, v67
    v_exp_f32 v60, v68
    v_exp_f32 v61, v69
    v_exp_f32 v62, v70
    v_exp_f32 v63, v71
    v_pk_add_f32 v[56:57], v[56:57], 1.0 op_sel_hi:[1,0]
    v_pk_add_f32 v[58:59], v[58:59], 1.0 op_sel_hi:[1,0]
    v_pk_add_f32 v[60:61], v[60:61], 1.0 op_sel_hi:[1,0]
    v_pk_add_f32 v[62:63], v[62:63], 1.0 op_sel_hi:[1,0]
    v_pk_add_f32 v[34:35], v[34:35], v[8:9] op_sel_hi:[1,0]
    ds_read_u16_d16_hi v38, v9 offset:3334
    ds_read_u16_d16_hi v39, v9 offset:3462
    ds_read_b64_tr_b16 v[32:33], v34 offset:3080
    ds_read_b64_tr_b16 v[34:35], v35 offset:3208
    v_mfma_f32_32x32x16_bf16 v[80:95], v[20:23], v[28:31], v[40:55]
    v_rcp_f32 v56, v56
    v_rcp_f32 v57, v57
    v_rcp_f32 v58, v58
    v_rcp_f32 v59, v59
    v_rcp_f32 v60, v60
    v_rcp_f32 v61, v61
    v_rcp_f32 v62, v62
    v_rcp_f32 v63, v63
    v_pk_mul_f32 v[56:57], v[56:57], v[64:65]
    v_pk_mul_f32 v[58:59], v[58:59], v[66:67]
    v_pk_mul_f32 v[60:61], v[60:61], v[68:69]
    v_pk_mul_f32 v[62:63], v[62:63], v[70:71]
    ds_read_u16 v3, v6 offset:3590
    v_cvt_pk_bf16_f32 v64, v56, v57
    v_cvt_pk_bf16_f32 v65, v58, v59
    v_cvt_pk_bf16_f32 v66, v60, v61
    v_cvt_pk_bf16_f32 v67, v62, v63
    v_exp_f32_e64 v56, v72
    v_exp_f32 v57, v73
    s_waitcnt lgkmcnt(1)
    v_mfma_f32_32x32x16_bf16 v[96:111], v[64:67], v[32:35], v[96:111]
    v_exp_f32 v58, v74
    v_exp_f32 v59, v75
    v_exp_f32 v60, v76
    v_exp_f32 v61, v77
    v_exp_f32 v62, v78
    v_exp_f32 v63, v79
    v_pk_add_f32 v[56:57], v[56:57], 1.0 op_sel_hi:[1,0]
    v_pk_add_f32 v[58:59], v[58:59], 1.0 op_sel_hi:[1,0]
    v_pk_add_f32 v[60:61], v[60:61], 1.0 op_sel_hi:[1,0]
    v_pk_add_f32 v[62:63], v[62:63], 1.0 op_sel_hi:[1,0]
    v_pk_add_f32 v[38:39], v[38:39], v[8:9] op_sel_hi:[1,0]
    ds_read_b64_tr_b16 v[36:37], v38 offset:3336
    ds_read_b64_tr_b16 v[38:39], v39 offset:3464
    s_waitcnt lgkmcnt(2)
    s_mov_b32 exec_lo, 0
    ds_read_b128 v[20:23], v3
    s_not_b64 exec, exec
    ds_read_b32 v20, v6 offset:3584
    s_mov_b64 exec, -1
    v_rcp_f32 v56, v56
    v_rcp_f32 v57, v57
    v_rcp_f32 v58, v58
    v_rcp_f32 v59, v59
    v_rcp_f32 v60, v60
    v_rcp_f32 v61, v61
    v_rcp_f32 v62, v62
    v_rcp_f32 v63, v63
    v_pk_mul_f32 v[56:57], v[56:57], v[72:73]
    v_pk_mul_f32 v[58:59], v[58:59], v[74:75]
    v_pk_mul_f32 v[60:61], v[60:61], v[76:77]
    v_pk_mul_f32 v[62:63], v[62:63], v[78:79]
    v_cvt_pk_bf16_f32 v72, v56, v57
    v_cvt_pk_bf16_f32 v73, v58, v59
    v_cvt_pk_bf16_f32 v74, v60, v61
    v_cvt_pk_bf16_f32 v75, v62, v63
    v_exp_f32_e64 v56, v80
    v_exp_f32 v57, v81
    s_waitcnt lgkmcnt(2)
    v_mfma_f32_32x32x16_bf16 v[96:111], v[72:75], v[36:39], v[96:111]
    v_exp_f32 v58, v82
    v_exp_f32 v59, v83
    v_exp_f32 v60, v84
    v_exp_f32 v61, v85
    v_exp_f32 v62, v86
    v_exp_f32 v63, v87
    v_pk_add_f32 v[56:57], v[56:57], 1.0 op_sel_hi:[1,0]
    v_pk_add_f32 v[58:59], v[58:59], 1.0 op_sel_hi:[1,0]
    v_pk_add_f32 v[60:61], v[60:61], 1.0 op_sel_hi:[1,0]
    v_pk_add_f32 v[62:63], v[62:63], 1.0 op_sel_hi:[1,0]
    v_rcp_f32 v56, v56
    v_rcp_f32 v57, v57
    v_rcp_f32 v58, v58
    v_rcp_f32 v59, v59
    v_rcp_f32 v60, v60
    v_rcp_f32 v61, v61
    v_rcp_f32 v62, v62
    v_rcp_f32 v63, v63
    v_pk_mul_f32 v[56:57], v[56:57], v[80:81]
    v_pk_mul_f32 v[58:59], v[58:59], v[82:83]
    v_pk_mul_f32 v[60:61], v[60:61], v[84:85]
    v_pk_mul_f32 v[62:63], v[62:63], v[86:87]
    s_waitcnt vmcnt(0)
    ds_read_b64_tr_b16 v[64:65], v4 offset:0
    ds_read_b64_tr_b16 v[66:67], v4 offset:256
    ds_read_b64_tr_b16 v[68:69], v4 offset:1024
    ds_read_b64_tr_b16 v[70:71], v4 offset:1280
    ds_read_b64_tr_b16 v[72:73], v4 offset:2048
    ds_read_b64_tr_b16 v[74:75], v4 offset:2304
    ds_read_b64_tr_b16 v[76:77], v4 offset:3072
    ds_read_b64_tr_b16 v[78:79], v4 offset:3328
    v_cvt_pk_bf16_f32 v80, v56, v57
    v_cvt_pk_bf16_f32 v81, v58, v59
    v_cvt_pk_bf16_f32 v82, v60, v61
    v_cvt_pk_bf16_f32 v83, v62, v63
    v_exp_f32 v56, v88
    v_exp_f32_e64 v57, v89
    v_mfma_f32_32x32x16_bf16 v[112:127], v[80:83], v[32:35], v[112:127]
    v_exp_f32 v58, v90
    v_exp_f32 v59, v91
    v_exp_f32 v60, v92
    v_exp_f32 v61, v93
    v_exp_f32 v62, v94
    v_exp_f32 v63, v95
    v_pk_add_f32 v[56:57], v[56:57], 1.0 op_sel_hi:[1,0]
    v_pk_add_f32 v[58:59], v[58:59], 1.0 op_sel_hi:[1,0]
    v_pk_add_f32 v[60:61], v[60:61], 1.0 op_sel_hi:[1,0]
    v_pk_add_f32 v[62:63], v[62:63], 1.0 op_sel_hi:[1,0]
    ds_read_b64_tr_b16 v[40:41], v4 offset:64
    ds_read_b64_tr_b16 v[42:43], v4 offset:320
    ds_read_b64_tr_b16 v[44:45], v4 offset:1088
    ds_read_b64_tr_b16 v[46:47], v4 offset:1344
    ds_read_b64_tr_b16 v[48:49], v4 offset:2112
    ds_read_b64_tr_b16 v[50:51], v4 offset:2368
    ds_read_b64_tr_b16 v[52:53], v4 offset:3136
    ds_read_b64_tr_b16 v[54:55], v4 offset:3392
    s_waitcnt lgkmcnt(8)
    v_mfma_f32_32x32x16_bf16 v[64:79], v[20:23], v[24:27], v[64:79]
    v_rcp_f32 v56, v56
    v_rcp_f32 v57, v57
    v_rcp_f32 v58, v58
    v_rcp_f32 v59, v59
    v_rcp_f32 v60, v60
    v_rcp_f32 v61, v61
    v_rcp_f32 v62, v62
    v_rcp_f32_e64 v63, v63
    v_pk_mul_f32 v[56:57], v[56:57], v[88:89]
    v_pk_mul_f32 v[58:59], v[58:59], v[90:91]
    v_pk_mul_f32 v[60:61], v[60:61], v[92:93]
    v_pk_mul_f32 v[62:63], v[62:63], v[94:95]
    ds_read_u16_d16_hi v34, v9 offset:3590
    ds_read_u16_d16_hi v35, v9 offset:3718
    v_cvt_pk_bf16_f32 v88, v56, v57
    v_cvt_pk_bf16_f32 v89, v58, v59
    v_cvt_pk_bf16_f32 v90, v60, v61
    v_cvt_pk_bf16_f32 v91, v62, v63
L_last:
    s_cmp_lt_u32 s63, 1
    s_cbranch_scc1 L_pr0
    s_setprio 1
L_pr0:
    s_cmp_lt_u32 s74, 4
    s_cbranch_scc1 L_lastlo
    s_cmp_eq_u32 s74, 4
    s_cbranch_scc1 L_last5
    s_cmp_eq_u32 s74, 5
    s_cbranch_scc1 L_last6
    s_cmp_eq_u32 s74, 6
    s_cbranch_scc1 L_last7
    v_exp_f32 v56, v64
    v_exp_f32 v57, v65
    s_waitcnt lgkmcnt(0)
    v_mfma_f32_32x32x16_bf16 v[112:127], v[88:91], v[36:39], v[112:127]
    v_exp_f32 v58, v66
    v_exp_f32 v59, v67
    v_exp_f32 v60, v68
    v_exp_f32 v61, v69
    v_exp_f32 v62, v70
    v_exp_f32 v63, v71
    v_pk_add_f32 v[56:57], v[56:57], 1.0 op_sel_hi:[1,0]
    v_pk_add_f32 v[58:59], v[58:59], 1.0 op_sel_hi:[1,0]
    v_pk_add_f32 v[60:61], v[60:61], 1.0 op_sel_hi:[1,0]
    v_pk_add_f32 v[62:63], v[62:63], 1.0 op_sel_hi:[1,0]
    v_pk_add_f32 v[34:35], v[34:35], v[8:9] op_sel_hi:[1,0]
    ds_read_u16_d16_hi v38, v9 offset:3846
    ds_read_u16_d16_hi v39, v9 offset:3974
    ds_read_b64_tr_b16 v[32:33], v34 offset:3592
    ds_read_b64_tr_b16 v[34:35], v35 offset:3720
    v_mfma_f32_32x32x16_bf16 v[80:95], v[20:23], v[28:31], v[40:55]
    v_rcp_f32 v56, v56
    v_rcp_f32 v57, v57
    v_rcp_f32 v58, v58
    v_rcp_f32 v59, v59
    v_rcp_f32 v60, v60
    v_rcp_f32 v61, v61
    v_rcp_f32 v62, v62
    v_rcp_f32 v63, v63
    v_pk_mul_f32 v[56:57], v[56:57], v[64:65]
    v_pk_mul_f32 v[58:59], v[58:59], v[66:67]
    v_pk_mul_f32 v[60:61], v[60:61], v[68:69]
    v_pk_mul_f32 v[62:63], v[62:63], v[70:71]
    v_cvt_pk_bf16_f32 v64, v56, v57
    v_cvt_pk_bf16_f32 v65, v58, v59
    v_cvt_pk_bf16_f32 v66, v60, v61
    v_cvt_pk_bf16_f32 v67, v62, v63
    s_waitcnt lgkmcnt(0)
    v_exp_f32 v56, v72
    v_exp_f32 v57, v73
    v_exp_f32 v58, v74
    v_exp_f32 v59, v75
    v_exp_f32 v60, v76
    v_exp_f32 v61, v77
    v_exp_f32 v62, v78
    v_exp_f32_e64 v63, v79
    v_pk_add_f32 v[56:57], v[56:57], 1.0 op_sel_hi:[1,0]
    v_pk_add_f32 v[58:59], v[58:59], 1.0 op_sel_hi:[1,0]
    v_pk_add_f32 v[60:61], v[60:61], 1.0 op_sel_hi:[1,0]
    v_pk_add_f32 v[62:63], v[62:63], 1.0 op_sel_hi:[1,0]
    v_pk_add_f32 v[38:39], v[38:39], v[8:9] op_sel_hi:[1,0]
    ds_read_b64_tr_b16 v[36:37], v38 offset:3848
    ds_read_b64_tr_b16 v[38:39], v39 offset:3976
    v_rcp_f32 v56, v56
    v_rcp_f32 v57, v57
    v_rcp_f32 v58, v58
    v_rcp_f32 v59, v59
    v_rcp_f32 v60, v60
    v_rcp_f32 v61, v61
    v_rcp_f32 v62, v62
    v_rcp_f32 v63, v63
    v_pk_mul_f32 v[56:57], v[56:57], v[72:73]
    v_pk_mul_f32 v[58:59], v[58:59], v[74:75]
    v_pk_mul_f32 v[60:61], v[60:61], v[76:77]
    v_pk_mul_f32 v[62:63], v[62:63], v[78:79]
    v_cvt_pk_bf16_f32 v72, v56, v57
    v_cvt_pk_bf16_f32 v73, v58, v59
    v_cvt_pk_bf16_f32 v74, v60, v61
    v_cvt_pk_bf16_f32 v75, v62, v63
    v_mfma_f32_32x32x16_bf16 v[96:111], v[64:67], v[32:35], v[96:111]
    v_exp_f32 v56, v80
    v_exp_f32 v57, v81
    v_exp_f32 v58, v82
    v_exp_f32 v59, v83
    v_exp_f32 v60, v84
    v_exp_f32 v61, v85
    v_exp_f32 v62, v86
    v_exp_f32 v63, v87
    v_pk_add_f32 v[56:57], v[56:57], 1.0 op_sel_hi:[1,0]
    v_pk_add_f32 v[58:59], v[58:59], 1.0 op_sel_hi:[1,0]
    v_pk_add_f32 v[60:61], v[60:61], 1.0 op_sel_hi:[1,0]
    v_pk_add_f32 v[62:63], v[62:63], 1.0 op_sel_hi:[1,0]
    s_waitcnt lgkmcnt(0)
    v_mfma_f32_32x32x16_bf16 v[96:111], v[72:75], v[36:39], v[96:111]
    v_rcp_f32 v56, v56
    v_rcp_f32 v57, v57
    v_rcp_f32 v58, v58
    v_rcp_f32 v59, v59
    v_rcp_f32 v60, v60
    v_rcp_f32 v61, v61
    v_rcp_f32 v62, v62
    v_rcp_f32_e64 v63, v63
    v_pk_mul_f32 v[56:57], v[56:57], v[80:81]
    v_pk_mul_f32 v[58:59], v[58:59], v[82:83]
    v_pk_mul_f32 v[60:61], v[60:61], v[84:85]
    v_pk_mul_f32 v[62:63], v[62:63], v[86:87]
    v_cvt_pk_bf16_f32 v80, v56, v57
    v_cvt_pk_bf16_f32 v81, v58, v59
    v_cvt_pk_bf16_f32 v82, v60, v61
    v_cvt_pk_bf16_f32 v83, v62, v63
    v_exp_f32 v56, v88
    v_exp_f32 v57, v89
    v_exp_f32 v58, v90
    v_exp_f32 v59, v91
    v_exp_f32 v60, v92
    v_exp_f32 v61, v93
    v_exp_f32 v62, v94
    v_exp_f32 v63, v95
    v_pk_add_f32 v[56:57], v[56:57], 1.0 op_sel_hi:[1,0]
    v_pk_add_f32 v[58:59], v[58:59], 1.0 op_sel_hi:[1,0]
    v_pk_add_f32 v[60:61], v[60:61], 1.0 op_sel_hi:[1,0]
    v_pk_add_f32 v[62:63], v[62:63], 1.0 op_sel_hi:[1,0]
    v_rcp_f32 v56, v56
    v_rcp_f32 v57, v57
    v_rcp_f32 v58, v58
    v_rcp_f32 v59, v59
    v_rcp_f32 v60, v60
    v_rcp_f32 v61, v61
    v_rcp_f32 v62, v62
    v_rcp_f32 v63, v63
    v_pk_mul_f32 v[56:57], v[56:57], v[88:89]
    v_pk_mul_f32 v[58:59], v[58:59], v[90:91]
    v_pk_mul_f32 v[60:61], v[60:61], v[92:93]
    v_pk_mul_f32 v[62:63], v[62:63], v[94:95]
    v_mfma_f32_32x32x16_bf16 v[112:127], v[80:83], v[32:35], v[112:127]
    v_cvt_pk_bf16_f32 v88, v56, v57
    v_cvt_pk_bf16_f32 v89, v58, v59
    v_cvt_pk_bf16_f32 v90, v60, v61
    v_cvt_pk_bf16_f32 v91, v62, v63
    s_nop 1
    v_mfma_f32_32x32x16_bf16 v[112:127], v[88:91], v[36:39], v[112:127]
    s_branch L_done
L_last7:
    v_exp_f32_e64 v56, v64
    v_exp_f32 v57, v65
    s_waitcnt lgkmcnt(0)
    v_mfma_f32_32x32x16_bf16 v[112:127], v[88:91], v[36:39], v[112:127]
    v_exp_f32 v58, v66
    v_exp_f32 v59, v67
    v_exp_f32 v60, v68
    v_exp_f32 v61, v69
    v_exp_f32 v62, v70
    v_exp_f32 v63, v71
    v_pk_add_f32 v[56:57], v[56:57], 1.0 op_sel_hi:[1,0]
    v_pk_add_f32 v[58:59], v[58:59], 1.0 op_sel_hi:[1,0]
    v_pk_add_f32 v[60:61], v[60:61], 1.0 op_sel_hi:[1,0]
    v_pk_add_f32 v[62:63], v[62:63], 1.0 op_sel_hi:[1,0]
    v_pk_add_f32 v[34:35], v[34:35], v[8:9] op_sel_hi:[1,0]
    ds_read_u16_d16_hi v38, v9 offset:3846
    ds_read_u16_d16_hi v39, v9 offset:3974
    ds_read_b64_tr_b16 v[32:33], v34 offset:3592
    ds_read_b64_tr_b16 v[34:35], v35 offset:3720
    v_mfma_f32_32x32x16_bf16 v[80:95], v[20:23], v[28:31], v[40:55]
    v_rcp_f32 v56, v56
    v_rcp_f32 v57, v57
    v_rcp_f32 v58, v58
    v_rcp_f32 v59, v59
    v_rcp_f32 v60, v60
    v_rcp_f32 v61, v61
    v_rcp_f32 v62, v62
    v_rcp_f32 v63, v63
    v_pk_mul_f32 v[56:57], v[56:57], v[64:65]
    v_pk_mul_f32 v[58:59], v[58:59], v[66:67]
    v_pk_mul_f32 v[60:61], v[60:61], v[68:69]
    v_pk_mul_f32 v[62:63], v[62:63], v[70:71]
    v_cvt_pk_bf16_f32 v64, v56, v57
    v_cvt_pk_bf16_f32 v65, v58, v59
    v_cvt_pk_bf16_f32 v66, v60, v61
    v_cvt_pk_bf16_f32 v67, v62, v63
    s_waitcnt lgkmcnt(0)
    v_exp_f32 v56, v72
    v_exp_f32 v57, v73
    v_exp_f32 v58, v74
    v_exp_f32 v59, v75
    v_exp_f32 v60, v76
    v_exp_f32_e64 v61, v77
    v_pk_add_f32 v[56:57], v[56:57], 1.0 op_sel_hi:[1,0]
    v_pk_add_f32 v[58:59], v[58:59], 1.0 op_sel_hi:[1,0]
    v_pk_add_f32 v[60:61], v[60:61], 1.0 op_sel_hi:[1,0]
    v_pk_add_f32 v[38:39], v[38:39], v[8:9] op_sel_hi:[1,0]
    ds_read_b64_tr_b16 v[36:37], v38 offset:3848
    ds_read_b64_tr_b16 v[38:39], v39 offset:3976
    v_rcp_f32 v56, v56
    v_rcp_f32 v57, v57
    v_rcp_f32 v58, v58
    v_rcp_f32 v59, v59
    v_rcp_f32 v60, v60
    v_rcp_f32 v61, v61
    v_pk_mul_f32 v[56:57], v[56:57], v[72:73]
    v_pk_mul_f32 v[58:59], v[58:59], v[74:75]
    v_pk_mul_f32 v[60:61], v[60:61], v[76:77]
    v_cvt_pk_bf16_f32 v72, v56, v57
    v_cvt_pk_bf16_f32 v73, v58, v59
    v_cvt_pk_bf16_f32 v74, v60, v61
    v_mov_b32_e64 v75, 0
    v_mfma_f32_32x32x16_bf16 v[96:111], v[64:67], v[32:35], v[96:111]
    v_exp_f32 v56, v80
    v_exp_f32 v57, v81
    v_exp_f32 v58, v82
    v_exp_f32 v59, v83
    v_exp_f32 v60, v84
    v_exp_f32 v61, v85
    v_exp_f32 v62, v86
    v_exp_f32 v63, v87
    v_pk_add_f32 v[56:57], v[56:57], 1.0 op_sel_hi:[1,0]
    v_pk_add_f32 v[58:59], v[58:59], 1.0 op_sel_hi:[1,0]
    v_pk_add_f32 v[60:61], v[60:61], 1.0 op_sel_hi:[1,0]
    v_pk_add_f32 v[62:63], v[62:63], 1.0 op_sel_hi:[1,0]
    s_waitcnt lgkmcnt(0)
    v_mfma_f32_32x32x16_bf16 v[96:111], v[72:75], v[36:39], v[96:111]
    v_rcp_f32 v56, v56
    v_rcp_f32 v57, v57
    v_rcp_f32 v58, v58
    v_rcp_f32 v59, v59
    v_rcp_f32 v60, v60
    v_rcp_f32 v61, v61
    v_rcp_f32 v62, v62
    v_rcp_f32_e64 v63, v63
    v_pk_mul_f32 v[56:57], v[56:57], v[80:81]
    v_pk_mul_f32 v[58:59], v[58:59], v[82:83]
    v_pk_mul_f32 v[60:61], v[60:61], v[84:85]
    v_pk_mul_f32 v[62:63], v[62:63], v[86:87]
    v_cvt_pk_bf16_f32 v80, v56, v57
    v_cvt_pk_bf16_f32 v81, v58, v59
    v_cvt_pk_bf16_f32 v82, v60, v61
    v_cvt_pk_bf16_f32 v83, v62, v63
    v_exp_f32 v56, v88
    v_exp_f32 v57, v89
    v_exp_f32 v58, v90
    v_exp_f32 v59, v91
    v_exp_f32 v60, v92
    v_exp_f32 v61, v93
    v_pk_add_f32 v[56:57], v[56:57], 1.0 op_sel_hi:[1,0]
    v_pk_add_f32 v[58:59], v[58:59], 1.0 op_sel_hi:[1,0]
    v_pk_add_f32 v[60:61], v[60:61], 1.0 op_sel_hi:[1,0]
    v_rcp_f32 v56, v56
    v_rcp_f32 v57, v57
    v_rcp_f32 v58, v58
    v_rcp_f32 v59, v59
    v_rcp_f32 v60, v60
    v_rcp_f32 v61, v61
    v_pk_mul_f32 v[56:57], v[56:57], v[88:89]
    v_pk_mul_f32 v[58:59], v[58:59], v[90:91]
    v_pk_mul_f32 v[60:61], v[60:61], v[92:93]
    v_mfma_f32_32x32x16_bf16 v[112:127], v[80:83], v[32:35], v[112:127]
    v_cvt_pk_bf16_f32 v88, v56, v57
    v_cvt_pk_bf16_f32 v89, v58, v59
    v_cvt_pk_bf16_f32 v90, v60, v61
    v_mov_b32 v91, 0
    s_nop 1
    v_mfma_f32_32x32x16_bf16 v[112:127], v[88:91], v[36:39], v[112:127]
    s_branch L_done
L_last6:
    v_exp_f32 v56, v64
    v_exp_f32 v57, v65
    s_waitcnt lgkmcnt(0)
    v_mfma_f32_32x32x16_bf16 v[112:127], v[88:91], v[36:39], v[112:127]
    v_exp_f32 v58, v66
    v_exp_f32 v59, v67
    v_exp_f32 v60, v68
    v_exp_f32 v61, v69
    v_exp_f32 v62, v70
    v_exp_f32 v63, v71
    v_pk_add_f32 v[56:57], v[56:57], 1.0 op_sel_hi:[1,0]
    v_pk_add_f32 v[58:59], v[58:59], 1.0 op_sel_hi:[1,0]
    v_pk_add_f32 v[60:61], v[60:61], 1.0 op_sel_hi:[1,0]
    v_pk_add_f32 v[62:63], v[62:63], 1.0 op_sel_hi:[1,0]
    v_pk_add_f32 v[34:35], v[34:35], v[8:9] op_sel_hi:[1,0]
    ds_read_u16_d16_hi v38, v9 offset:3846
    ds_read_u16_d16_hi v39, v9 offset:3974
    ds_read_b64_tr_b16 v[32:33], v34 offset:3592
    ds_read_b64_tr_b16 v[34:35], v35 offset:3720
    v_mfma_f32_32x32x16_bf16 v[80:95], v[20:23], v[28:31], v[40:55]
    v_rcp_f32 v56, v56
    v_rcp_f32 v57, v57
    v_rcp_f32 v58, v58
    v_rcp_f32 v59, v59
    v_rcp_f32 v60, v60
    v_rcp_f32 v61, v61
    v_rcp_f32 v62, v62
    v_rcp_f32 v63, v63
    v_pk_mul_f32 v[56:57], v[56:57], v[64:65]
    v_pk_mul_f32 v[58:59], v[58:59], v[66:67]
    v_pk_mul_f32 v[60:61], v[60:61], v[68:69]
    v_pk_mul_f32 v[62:63], v[62:63], v[70:71]
    v_cvt_pk_bf16_f32 v64, v56, v57
    v_cvt_pk_bf16_f32 v65, v58, v59
    v_cvt_pk_bf16_f32 v66, v60, v61
    v_cvt_pk_bf16_f32 v67, v62, v63
    s_waitcnt lgkmcnt(0)
    v_exp_f32 v56, v72
    v_exp_f32 v57, v73
    v_exp_f32 v58, v74
    v_exp_f32_e64 v59, v75
    v_pk_add_f32 v[56:57], v[56:57], 1.0 op_sel_hi:[1,0]
    v_pk_add_f32 v[58:59], v[58:59], 1.0 op_sel_hi:[1,0]
    v_pk_add_f32 v[38:39], v[38:39], v[8:9] op_sel_hi:[1,0]
    ds_read_b64_tr_b16 v[36:37], v38 offset:3848
    ds_read_b64_tr_b16 v[38:39], v39 offset:3976
    v_rcp_f32 v56, v56
    v_rcp_f32 v57, v57
    v_rcp_f32 v58, v58
    v_rcp_f32 v59, v59
    v_pk_mul_f32 v[56:57], v[56:57], v[72:73]
    v_pk_mul_f32 v[58:59], v[58:59], v[74:75]
    v_cvt_pk_bf16_f32 v72, v56, v57
    v_cvt_pk_bf16_f32 v73, v58, v59
    v_mov_b64_e64 v[74:75], 0
    v_mfma_f32_32x32x16_bf16 v[96:111], v[64:67], v[32:35], v[96:111]
    v_exp_f32 v56, v80
    v_exp_f32 v57, v81
    v_exp_f32 v58, v82
    v_exp_f32 v59, v83
    v_exp_f32 v60, v84
    v_exp_f32 v61, v85
    v_exp_f32 v62, v86
    v_exp_f32 v63, v87
    v_pk_add_f32 v[56:57], v[56:57], 1.0 op_sel_hi:[1,0]
    v_pk_add_f32 v[58:59], v[58:59], 1.0 op_sel_hi:[1,0]
    v_pk_add_f32 v[60:61], v[60:61], 1.0 op_sel_hi:[1,0]
    v_pk_add_f32 v[62:63], v[62:63], 1.0 op_sel_hi:[1,0]
    s_waitcnt lgkmcnt(0)
    v_mfma_f32_32x32x16_bf16 v[96:111], v[72:75], v[36:39], v[96:111]
    v_rcp_f32 v56, v56
    v_rcp_f32 v57, v57
    v_rcp_f32 v58, v58
    v_rcp_f32 v59, v59
    v_rcp_f32 v60, v60
    v_rcp_f32 v61, v61
    v_rcp_f32 v62, v62
    v_rcp_f32_e64 v63, v63
    v_pk_mul_f32 v[56:57], v[56:57], v[80:81]
    v_pk_mul_f32 v[58:59], v[58:59], v[82:83]
    v_pk_mul_f32 v[60:61], v[60:61], v[84:85]
    v_pk_mul_f32 v[62:63], v[62:63], v[86:87]
    v_cvt_pk_bf16_f32 v80, v56, v57
    v_cvt_pk_bf16_f32 v81, v58, v59
    v_cvt_pk_bf16_f32 v82, v60, v61
    v_cvt_pk_bf16_f32 v83, v62, v63
    v_exp_f32 v56, v88
    v_exp_f32 v57, v89
    v_exp_f32 v58, v90
    v_exp_f32 v59, v91
    v_pk_add_f32 v[56:57], v[56:57], 1.0 op_sel_hi:[1,0]
    v_pk_add_f32 v[58:59], v[58:59], 1.0 op_sel_hi:[1,0]
    v_rcp_f32 v56, v56
    v_rcp_f32 v57, v57
    v_rcp_f32 v58, v58
    v_rcp_f32 v59, v59
    v_pk_mul_f32 v[56:57], v[56:57], v[88:89]
    v_pk_mul_f32 v[58:59], v[58:59], v[90:91]
    v_mfma_f32_32x32x16_bf16 v[112:127], v[80:83], v[32:35], v[112:127]
    v_cvt_pk_bf16_f32 v88, v56, v57
    v_cvt_pk_bf16_f32 v89, v58, v59
    v_mov_b64 v[90:91], 0
    s_nop 1
    v_mfma_f32_32x32x16_bf16 v[112:127], v[88:91], v[36:39], v[112:127]
    s_branch L_done
L_last5:
    v_exp_f32 v56, v64
    v_exp_f32 v57, v65
    s_waitcnt lgkmcnt(0)
    v_mfma_f32_32x32x16_bf16 v[112:127], v[88:91], v[36:39], v[112:127]
    v_exp_f32 v58, v66
    v_exp_f32 v59, v67
    v_exp_f32 v60, v68
    v_exp_f32 v61, v69
    v_exp_f32 v62, v70
    v_exp_f32 v63, v71
    v_pk_add_f32 v[56:57], v[56:57], 1.0 op_sel_hi:[1,0]
    v_pk_add_f32 v[58:59], v[58:59], 1.0 op_sel_hi:[1,0]
    v_pk_add_f32 v[60:61], v[60:61], 1.0 op_sel_hi:[1,0]
    v_pk_add_f32 v[62:63], v[62:63], 1.0 op_sel_hi:[1,0]
    v_pk_add_f32 v[34:35], v[34:35], v[8:9] op_sel_hi:[1,0]
    ds_read_u16_d16_hi v38, v9 offset:3846
    ds_read_u16_d16_hi v39, v9 offset:3974
    ds_read_b64_tr_b16 v[32:33], v34 offset:3592
    ds_read_b64_tr_b16 v[34:35], v35 offset:3720
    v_mfma_f32_32x32x16_bf16 v[80:95], v[20:23], v[28:31], v[40:55]
    v_rcp_f32 v56, v56
    v_rcp_f32 v57, v57
    v_rcp_f32 v58, v58
    v_rcp_f32 v59, v59
    v_rcp_f32 v60, v60
    v_rcp_f32 v61, v61
    v_rcp_f32 v62, v62
    v_rcp_f32 v63, v63
    v_pk_mul_f32 v[56:57], v[56:57], v[64:65]
    v_pk_mul_f32 v[58:59], v[58:59], v[66:67]
    v_pk_mul_f32 v[60:61], v[60:61], v[68:69]
    v_pk_mul_f32 v[62:63], v[62:63], v[70:71]
    v_cvt_pk_bf16_f32 v64, v56, v57
    v_cvt_pk_bf16_f32 v65, v58, v59
    v_cvt_pk_bf16_f32 v66, v60, v61
    v_cvt_pk_bf16_f32 v67, v62, v63
    s_waitcnt lgkmcnt(0)
    v_exp_f32 v56, v72
    v_exp_f32 v57, v73
    s_nop 0
    v_pk_add_f32 v[56:57], v[56:57], 1.0 op_sel_hi:[1,0]
    v_pk_add_f32 v[38:39], v[38:39], v[8:9] op_sel_hi:[1,0]
    ds_read_b64_tr_b16 v[36:37], v38 offset:3848
    ds_read_b64_tr_b16 v[38:39], v39 offset:3976
    v_rcp_f32_e64 v56, v56
    v_rcp_f32 v57, v57
    s_nop 0
    v_pk_mul_f32 v[56:57], v[56:57], v[72:73]
    v_cvt_pk_bf16_f32 v72, v56, v57
    v_mov_b32 v73, 0
    v_mov_b64 v[74:75], 0
    v_mfma_f32_32x32x16_bf16 v[96:111], v[64:67], v[32:35], v[96:111]
    v_exp_f32 v56, v80
    v_exp_f32 v57, v81
    v_exp_f32 v58, v82
    v_exp_f32 v59, v83
    v_exp_f32 v60, v84
    v_exp_f32 v61, v85
    v_exp_f32 v62, v86
    v_exp_f32 v63, v87
    v_pk_add_f32 v[56:57], v[56:57], 1.0 op_sel_hi:[1,0]
    v_pk_add_f32 v[58:59], v[58:59], 1.0 op_sel_hi:[1,0]
    v_pk_add_f32 v[60:61], v[60:61], 1.0 op_sel_hi:[1,0]
    v_pk_add_f32 v[62:63], v[62:63], 1.0 op_sel_hi:[1,0]
    s_waitcnt lgkmcnt(0)
    v_mfma_f32_32x32x16_bf16 v[96:111], v[72:75], v[36:39], v[96:111]
    v_rcp_f32 v56, v56
    v_rcp_f32 v57, v57
    v_rcp_f32 v58, v58
    v_rcp_f32 v59, v59
    v_rcp_f32 v60, v60
    v_rcp_f32 v61, v61
    v_rcp_f32 v62, v62
    v_rcp_f32_e64 v63, v63
    v_pk_mul_f32 v[56:57], v[56:57], v[80:81]
    v_pk_mul_f32 v[58:59], v[58:59], v[82:83]
    v_pk_mul_f32 v[60:61], v[60:61], v[84:85]
    v_pk_mul_f32 v[62:63], v[62:63], v[86:87]
    v_cvt_pk_bf16_f32 v80, v56, v57
    v_cvt_pk_bf16_f32 v81, v58, v59
    v_cvt_pk_bf16_f32 v82, v60, v61
    v_cvt_pk_bf16_f32 v83, v62, v63
    v_exp_f32_e64 v56, v88
    v_exp_f32 v57, v89
    s_nop 0
    v_pk_add_f32 v[56:57], v[56:57], 1.0 op_sel_hi:[1,0]
    v_rcp_f32_e64 v56, v56
    v_rcp_f32 v57, v57
    s_nop 0
    v_pk_mul_f32 v[56:57], v[56:57], v[88:89]
    v_mfma_f32_32x32x16_bf16 v[112:127], v[80:83], v[32:35], v[112:127]
    v_cvt_pk_bf16_f32 v88, v56, v57
    v_mov_b32_e64 v89, 0
    v_mov_b64 v[90:91], 0
    s_nop 1
    v_mfma_f32_32x32x16_bf16 v[112:127], v[88:91], v[36:39], v[112:127]
    s_branch L_done
L_lastlo:
    s_cmp_eq_u32 s74, 0
    s_cbranch_scc1 L_last1
    s_cmp_eq_u32 s74, 1
    s_cbranch_scc1 L_last2
    s_cmp_eq_u32 s74, 2
    s_cbranch_scc1 L_last3
    s_waitcnt lgkmcnt(0)
    v_mfma_f32_32x32x16_bf16 v[112:127], v[88:91], v[36:39], v[112:127]
    v_exp_f32 v56, v64
    v_exp_f32 v57, v65
    v_exp_f32 v58, v66
    v_exp_f32 v59, v67
    v_exp_f32 v60, v68
    v_exp_f32 v61, v69
    v_exp_f32 v62, v70
    v_exp_f32 v63, v71
    v_pk_add_f32 v[56:57], v[56:57], 1.0 op_sel_hi:[1,0]
    v_pk_add_f32 v[58:59], v[58:59], 1.0 op_sel_hi:[1,0]
    v_pk_add_f32 v[60:61], v[60:61], 1.0 op_sel_hi:[1,0]
    v_pk_add_f32 v[62:63], v[62:63], 1.0 op_sel_hi:[1,0]
    v_pk_add_f32 v[34:35], v[34:35], v[8:9] op_sel_hi:[1,0]
    ds_read_b64_tr_b16 v[32:33], v34 offset:3592
    ds_read_b64_tr_b16 v[34:35], v35 offset:3720
    v_mfma_f32_32x32x16_bf16 v[80:95], v[20:23], v[28:31], v[40:55]
    v_rcp_f32 v56, v56
    v_rcp_f32 v57, v57
    v_rcp_f32 v58, v58
    v_rcp_f32 v59, v59
    v_rcp_f32 v60, v60
    v_rcp_f32 v61, v61
    v_rcp_f32 v62, v62
    v_rcp_f32 v63, v63
    v_pk_mul_f32 v[56:57], v[56:57], v[64:65]
    v_pk_mul_f32 v[58:59], v[58:59], v[66:67]
    v_pk_mul_f32 v[60:61], v[60:61], v[68:69]
    v_pk_mul_f32 v[62:63], v[62:63], v[70:71]
    v_cvt_pk_bf16_f32 v64, v56, v57
    v_cvt_pk_bf16_f32 v65, v58, v59
    v_cvt_pk_bf16_f32 v66, v60, v61
    v_cvt_pk_bf16_f32 v67, v62, v63
    v_exp_f32 v56, v80
    v_exp_f32 v57, v81
    v_exp_f32 v58, v82
    v_exp_f32 v59, v83
    v_exp_f32 v60, v84
    v_exp_f32 v61, v85
    v_exp_f32 v62, v86
    v_exp_f32 v63, v87
    v_pk_add_f32 v[56:57], v[56:57], 1.0 op_sel_hi:[1,0]
    v_pk_add_f32 v[58:59], v[58:59], 1.0 op_sel_hi:[1,0]
    v_pk_add_f32 v[60:61], v[60:61], 1.0 op_sel_hi:[1,0]
    v_pk_add_f32 v[62:63], v[62:63], 1.0 op_sel_hi:[1,0]
    s_waitcnt lgkmcnt(0)
    v_mfma_f32_32x32x16_bf16 v[96:111], v[64:67], v[32:35], v[96:111]
    v_rcp_f32 v56, v56
    v_rcp_f32 v57, v57
    v_rcp_f32 v58, v58
    v_rcp_f32 v59, v59
    v_rcp_f32 v60, v60
    v_rcp_f32 v61, v61
    v_rcp_f32 v62, v62
    v_rcp_f32_e64 v63, v63
    v_pk_mul_f32 v[56:57], v[56:57], v[80:81]
    v_pk_mul_f32 v[58:59], v[58:59], v[82:83]
    v_pk_mul_f32 v[60:61], v[60:61], v[84:85]
    v_pk_mul_f32 v[62:63], v[62:63], v[86:87]
    v_cvt_pk_bf16_f32 v80, v56, v57
    v_cvt_pk_bf16_f32 v81, v58, v59
    v_cvt_pk_bf16_f32 v82, v60, v61
    v_cvt_pk_bf16_f32 v83, v62, v63
    s_nop 1
    v_mfma_f32_32x32x16_bf16 v[112:127], v[80:83], v[32:35], v[112:127]
    s_branch L_done
L_last3:
    s_waitcnt lgkmcnt(0)
    v_mfma_f32_32x32x16_bf16 v[112:127], v[88:91], v[36:39], v[112:127]
    v_exp_f32 v56, v64
    v_exp_f32 v57, v65
    v_exp_f32 v58, v66
    v_exp_f32 v59, v67
    v_exp_f32 v60, v68
    v_exp_f32_e64 v61, v69
    v_pk_add_f32 v[56:57], v[56:57], 1.0 op_sel_hi:[1,0]
    v_pk_add_f32 v[58:59], v[58:59], 1.0 op_sel_hi:[1,0]
    v_pk_add_f32 v[60:61], v[60:61], 1.0 op_sel_hi:[1,0]
    v_pk_add_f32 v[34:35], v[34:35], v[8:9] op_sel_hi:[1,0]
    ds_read_b64_tr_b16 v[32:33], v34 offset:3592
    ds_read_b64_tr_b16 v[34:35], v35 offset:3720
    v_mfma_f32_32x32x16_bf16 v[80:95], v[20:23], v[28:31], v[40:55]
    v_rcp_f32 v56, v56
    v_rcp_f32 v57, v57
    v_rcp_f32 v58, v58
    v_rcp_f32 v59, v59
    v_rcp_f32 v60, v60
    v_rcp_f32 v61, v61
    v_pk_mul_f32 v[56:57], v[56:57], v[64:65]
    v_pk_mul_f32 v[58:59], v[58:59], v[66:67]
    v_pk_mul_f32 v[60:61], v[60:61], v[68:69]
    v_cvt_pk_bf16_f32 v64, v56, v57
    v_cvt_pk_bf16_f32 v65, v58, v59
    v_cvt_pk_bf16_f32 v66, v60, v61
    v_mov_b32 v67, 0
    v_exp_f32 v56, v80
    v_exp_f32 v57, v81
    v_exp_f32 v58, v82
    v_exp_f32 v59, v83
    v_exp_f32 v60, v84
    v_exp_f32_e64 v61, v85
    v_pk_add_f32 v[56:57], v[56:57], 1.0 op_sel_hi:[1,0]
    v_pk_add_f32 v[58:59], v[58:59], 1.0 op_sel_hi:[1,0]
    v_pk_add_f32 v[60:61], v[60:61], 1.0 op_sel_hi:[1,0]
    s_waitcnt lgkmcnt(0)
    v_mfma_f32_32x32x16_bf16 v[96:111], v[64:67], v[32:35], v[96:111]
    v_rcp_f32 v56, v56
    v_rcp_f32 v57, v57
    v_rcp_f32 v58, v58
    v_rcp_f32 v59, v59
    v_rcp_f32 v60, v60
    v_rcp_f32_e64 v61, v61
    v_pk_mul_f32 v[56:57], v[56:57], v[80:81]
    v_pk_mul_f32 v[58:59], v[58:59], v[82:83]
    v_pk_mul_f32 v[60:61], v[60:61], v[84:85]
    v_cvt_pk_bf16_f32 v80, v56, v57
    v_cvt_pk_bf16_f32 v81, v58, v59
    v_cvt_pk_bf16_f32 v82, v60, v61
    v_mov_b32 v83, 0
    s_nop 1
    v_mfma_f32_32x32x16_bf16 v[112:127], v[80:83], v[32:35], v[112:127]
    s_branch L_done
L_last2:
    s_waitcnt lgkmcnt(0)
    v_mfma_f32_32x32x16_bf16 v[112:127], v[88:91], v[36:39], v[112:127]
    v_exp_f32_e64 v56, v64
    v_mfma_f32_32x32x16_bf16 v[80:95], v[20:23], v[28:31], v[40:55]
    v_exp_f32 v57, v65
    v_exp_f32 v58, v66
    v_exp_f32 v59, v67
    v_add_f32 v34, v34, v8
    v_add_f32_e64 v35, v35, v8
    ds_read_b64_tr_b16 v[32:33], v34 offset:3592
    ds_read_b64_tr_b16 v[34:35], v35 offset:3720
    v_add_f32 v56, 1.0, v56
    v_add_f32 v57, 1.0, v57
    v_add_f32 v58, 1.0, v58
    v_add_f32 v59, 1.0, v59
    v_rcp_f32 v56, v56
    v_rcp_f32 v57, v57
    v_rcp_f32 v58, v58
    v_rcp_f32 v59, v59
    v_mul_f32 v56, v56, v64
    v_mul_f32 v57, v57, v65
    v_mul_f32 v58, v58, v66
    v_mul_f32 v59, v59, v67
    v_cvt_pk_bf16_f32 v64, v56, v57
    v_cvt_pk_bf16_f32 v65, v58, v59
    v_mov_b64_e64 v[66:67], 0
    v_exp_f32 v56, v80
    s_waitcnt lgkmcnt(0)
    v_mfma_f32_32x32x16_bf16 v[96:111], v[64:67], v[32:35], v[96:111]
    v_exp_f32 v57, v81
    v_exp_f32 v58, v82
    v_exp_f32 v59, v83
    v_add_f32 v56, 1.0, v56
    v_add_f32 v57, 1.0, v57
    v_add_f32 v58, 1.0, v58
    v_add_f32 v59, 1.0, v59
    v_rcp_f32 v56, v56
    v_rcp_f32 v57, v57
    v_rcp_f32 v58, v58
    v_rcp_f32 v59, v59
    v_mul_f32 v56, v56, v80
    v_mul_f32 v57, v57, v81
    v_mul_f32 v58, v58, v82
    v_mul_f32_e64 v59, v59, v83
    v_cvt_pk_bf16_f32 v80, v56, v57
    v_cvt_pk_bf16_f32 v81, v58, v59
    v_mov_b64 v[82:83], 0
    s_nop 1
    v_mfma_f32_32x32x16_bf16 v[112:127], v[80:83], v[32:35], v[112:127]
    s_branch L_done
L_last1:
    s_waitcnt lgkmcnt(0)
    v_mfma_f32_32x32x16_bf16 v[112:127], v[88:91], v[36:39], v[112:127]
    v_exp_f32_e64 v56, v64
    v_mfma_f32_32x32x16_bf16 v[80:95], v[20:23], v[28:31], v[40:55]
    v_exp_f32 v57, v65
    v_add_f32 v34, v34, v8
    v_add_f32_e64 v35, v35, v8
    ds_read_b64_tr_b16 v[32:33], v34 offset:3592
    ds_read_b64_tr_b16 v[34:35], v35 offset:3720
    v_add_f32 v56, 1.0, v56
    v_add_f32 v57, 1.0, v57
    v_rcp_f32 v56, v56
    v_rcp_f32 v57, v57
    v_mul_f32 v56, v56, v64
    v_mul_f32 v57, v57, v65
    v_cvt_pk_bf16_f32 v64, v56, v57
    v_mov_b32 v65, 0
    v_mov_b64 v[66:67], 0
    v_exp_f32 v56, v80
    s_waitcnt lgkmcnt(0)
    v_mfma_f32_32x32x16_bf16 v[96:111], v[64:67], v[32:35], v[96:111]
    v_exp_f32 v57, v81
    v_add_f32 v56, 1.0, v56
    v_add_f32 v57, 1.0, v57
    v_rcp_f32 v56, v56
    v_rcp_f32 v57, v57
    v_mul_f32 v56, v56, v80
    v_mul_f32_e64 v57, v57, v81
    v_cvt_pk_bf16_f32 v80, v56, v57
    v_mov_b32_e64 v81, 0
    v_mov_b64 v[82:83], 0
    s_nop 1
    v_mfma_f32_32x32x16_bf16 v[112:127], v[80:83], v[32:35], v[112:127]
L_done:
    s_setprio 3
    s_cmp_lg_u32 s67, 0
    s_cbranch_scc1 L_again
    s_mov_b32 s10, 0x11111111
    s_mov_b32 s11, 0x11111111
    ds_read_b128 v[16:19], v5 offset:256
    ds_read_b128 v[20:23], v5 offset:288
    ds_read_b128 v[24:27], v5 offset:320
    ds_read_b128 v[28:31], v5 offset:352
    ds_read_b128 v[40:43], v5 offset:384
    ds_read_b128 v[44:47], v5 offset:416
    ds_read_b128 v[48:51], v5 offset:448
    ds_read_b128 v[52:55], v5 offset:480
    v_cvt_pk_bf16_f32 v64, v96, v97
    v_cvt_pk_bf16_f32 v65, v98, v99
    v_cvt_pk_bf16_f32 v66, v100, v101
    v_cvt_pk_bf16_f32 v67, v102, v103
    v_cvt_pk_bf16_f32 v68, v104, v105
    v_cvt_pk_bf16_f32 v69, v106, v107
    v_cvt_pk_bf16_f32 v70, v108, v109
    v_cvt_pk_bf16_f32 v71, v110, v111
    s_mov_b64 exec, s[10:11]
    ds_write_b128 v10, v[64:67]
    ds_write_b128 v10, v[68:71] offset:16
    s_mov_b64 exec, -1
    v_cvt_pk_bf16_f32 v72, v112, v113
    v_cvt_pk_bf16_f32 v73, v114, v115
    v_cvt_pk_bf16_f32 v74, v116, v117
    v_cvt_pk_bf16_f32 v75, v118, v119
    v_cvt_pk_bf16_f32 v76, v120, v121
    v_cvt_pk_bf16_f32 v77, v122, v123
    v_cvt_pk_bf16_f32 v78, v124, v125
    v_cvt_pk_bf16_f32 v79, v126, v127
    s_mov_b64 exec, s[10:11]
    ds_write_b128 v10, v[72:75] offset:64
    s_lshl_b32 s6, s63, 2
    ds_write_b128 v10, v[76:79] offset:80
    s_lshl_b64 exec, 1, s6
    ds_inc_u32 v0, v10 offset:208
    s_mov_b64 exec, -1
    s_cmp_eq_u32 s63, 0
    s_cbranch_scc1 L_ppr
    s_setprio 0
L_ppr:
    s_mov_b32 s7, 0xeeeeeeee
    s_mov_b32 exec_lo, s7
    s_mov_b32 exec_hi, 0
    buffer_load_short_d16_hi v86, v11, s[36:39], 0 offen
    s_mov_b64 exec, -1
    s_lshl_b32 s5, s100, 8
    s_mov_b32 m0, s5
    s_lshl_b32 s6, s61, 2
    s_xor_b32 s5, s5, 0x100
    s_waitcnt lgkmcnt(5)
    v_pk_mul_f32 v[80:81], v[96:97], v[16:17]
    v_pk_mul_f32 v[82:83], v[98:99], v[18:19]
    v_pk_fma_f32 v[80:81], v[100:101], v[20:21], v[80:81]
    v_pk_fma_f32 v[82:83], v[102:103], v[22:23], v[82:83]
    v_pk_fma_f32 v[80:81], v[104:105], v[24:25], v[80:81]
    v_pk_fma_f32 v[82:83], v[106:107], v[26:27], v[82:83]
    v_pk_fma_f32 v[80:81], v[108:109], v[28:29], v[80:81]
    v_pk_fma_f32 v[82:83], v[110:111], v[30:31], v[82:83]
    v_pk_fma_f32 v[80:81], v[112:113], v[40:41], v[80:81]
    v_pk_fma_f32 v[82:83], v[114:115], v[42:43], v[82:83]
    v_pk_fma_f32 v[80:81], v[116:117], v[44:45], v[80:81]
    v_pk_fma_f32 v[82:83], v[118:119], v[46:47], v[82:83]
    v_pk_fma_f32 v[80:81], v[120:121], v[48:49], v[80:81]
    v_pk_fma_f32 v[82:83], v[122:123], v[50:51], v[82:83]
    v_pk_fma_f32 v[80:81], v[124:125], v[52:53], v[80:81]
    v_pk_fma_f32 v[82:83], v[126:127], v[54:55], v[82:83]
    v_pk_add_f32 v[80:81], v[80:81], v[82:83]
    v_add_f32 v80, v80, v81
    ds_write_addtid_b32 v80 offset:4864
    ds_read_addtid_b32 v81 offset:4992
    s_lshl_b64 exec, 1, s6
    s_mov_b32 m0, s5
    ds_inc_rtn_u32 v87, v0, v10 offset:224
    s_mov_b32 exec_lo, s7
    ds_read_addtid_b32 v82 offset:4864
    ds_read_addtid_b32 v83 offset:4992
    s_waitcnt lgkmcnt(0)
    v_readlane_b32 s6, v87, s6
    s_cmp_eq_u32 s6, 0
    s_cbranch_scc1 L_nopos
    v_add_f32 v80, v80, v81
    v_add_f32 v82, v82, v83
    v_add_f32 v80, v80, v82
    s_waitcnt vmcnt(0)
    v_fmac_f32 v86, 0xbf317218, v80
    v_cvt_pk_bf16_f32 v86, v86, v86
    buffer_store_short v86, v11, s[56:59], 0 offen sc1
L_nopos:
    s_mov_b64 exec, -1
    s_cmp_lg_u32 s63, 0
    s_cbranch_scc1 L_exit
    s_lshl_b32 s6, s100, 10
    v_lshl_add_u32 v12, v0, 4, s6
    s_mul_i32 s5, s100, 15360
    s_add_u32 s5, s5, 10485760
    ds_read_b128 v[4:7], v12 offset:768
    s_waitcnt vmcnt(0)
    buffer_load_dwordx4 v[64:67], v12, s[40:43], s5 offen offset:0 sc1
    buffer_load_dwordx4 v[68:71], v12, s[40:43], s5 offen offset:1024 sc1
    buffer_load_dwordx4 v[72:75], v12, s[40:43], s5 offen offset:2048 sc1
    buffer_load_dwordx4 v[76:79], v12, s[40:43], s5 offen offset:3072 sc1
    s_add_u32 s5, s5, 4096
    buffer_load_dwordx4 v[80:83], v12, s[40:43], s5 offen offset:0 sc1
    buffer_load_dwordx4 v[84:87], v12, s[40:43], s5 offen offset:1024 sc1
    buffer_load_dwordx4 v[88:91], v12, s[40:43], s5 offen offset:2048 sc1
    buffer_load_dwordx4 v[92:95], v12, s[40:43], s5 offen offset:3072 sc1
    s_add_u32 s5, s5, 4096
    buffer_load_dwordx4 v[96:99], v12, s[40:43], s5 offen offset:0 sc1
    buffer_load_dwordx4 v[100:103], v12, s[40:43], s5 offen offset:1024 sc1
    buffer_load_dwordx4 v[104:107], v12, s[40:43], s5 offen offset:2048 sc1
    buffer_load_dwordx4 v[108:111], v12, s[40:43], s5 offen offset:3072 sc1
    s_add_u32 s5, s5, 4096
    buffer_load_dwordx4 v[112:115], v12, s[40:43], s5 offen offset:0 sc1
    buffer_load_dwordx4 v[116:119], v12, s[40:43], s5 offen offset:1024 sc1
    buffer_load_dwordx4 v[120:123], v12, s[40:43], s5 offen offset:2048 sc1
    buffer_load_dwordx4 v[124:127], v12, s[40:43], s5 offen offset:3072 sc1
    s_waitcnt lgkmcnt(0)
    v_xor_b32 v9, 64, v5
    v_xor_b32 v10, 0x80, v5
    v_xor_b32 v11, 0xc0, v5
    v_mov_b32 v1, 0
    v_mov_b32 v3, 55296
    s_movk_i32 s5, 0x110
    s_movk_i32 s6, 0x220
    s_movk_i32 s7, 0x330
    v_xad_u32 v61, v6, s5, v3
    v_xad_u32 v62, v6, s6, v3
    v_xad_u32 v63, v6, s7, v3
    v_add_u32 v6, v6, v3
    s_cmp_lt_u32 s3, 212
    s_cselect_b32 s12, -1, 0xffff
    v_mov_b32 v3, 88064
    s_waitcnt vmcnt(0)
    s_mov_b32 s10, 0xbfb8aa3b
    s_mov_b32 s11, 0xbfb8aa3b
    ds_read_b128 v[28:31], v5 offset:0
    ds_read_b128 v[32:35], v9 offset:0
    ds_read_b128 v[36:39], v10 offset:0
    ds_read_b128 v[40:43], v11 offset:0
    s_waitcnt lgkmcnt(0)
    v_mfma_f32_16x16x32_bf16 v[44:47], v[28:31], v[64:67], 0
    v_mfma_f32_16x16x32_bf16 v[48:51], v[28:31], v[96:99], 0
    v_mfma_f32_16x16x32_bf16 v[44:47], v[32:35], v[68:71], v[44:47]
    v_mfma_f32_16x16x32_bf16 v[48:51], v[32:35], v[100:103], v[48:51]
    v_mfma_f32_16x16x32_bf16 v[44:47], v[36:39], v[72:75], v[44:47]
    v_mfma_f32_16x16x32_bf16 v[48:51], v[36:39], v[104:107], v[48:51]
    v_mfma_f32_16x16x32_bf16 v[44:47], v[40:43], v[76:79], v[44:47]
    v_mfma_f32_16x16x32_bf16 v[48:51], v[40:43], v[108:111], v[48:51]
    s_setprio 3
    ds_read_b128 v[28:31], v5 offset:4096
    ds_read_b128 v[32:35], v9 offset:4096
    ds_read_b128 v[36:39], v10 offset:4096
    ds_read_b128 v[40:43], v11 offset:4096
    s_bfe_u32 s5, s98, 0x10000
    s_lshl_b32 s5, s5, 13
    v_xad_u32 v8, v4, s5, v3
    s_mov_b32 s72, 0x1000000
L_sw0:
    ds_read_b32 v60, v1 offset:208
    s_waitcnt lgkmcnt(0)
    v_readfirstlane_b32 s5, v60
    s_cmp_ge_u32 s5, 4
    s_cbranch_scc1 L_sg0
    s_sleep 1
    s_sub_u32 s72, s72, 1
    s_cbranch_scc0 L_sw0
L_sg0:
    ds_read_b128 v[12:15], v8 offset:0
    ds_read_b128 v[16:19], v8 offset:64
    ds_read_b128 v[20:23], v8 offset:4096
    ds_read_b128 v[24:27], v8 offset:4160
    s_waitcnt lgkmcnt(3)
    v_mfma_f32_16x16x32_bf16 v[44:47], v[12:15], v[80:83], v[44:47]
    v_mfma_f32_16x16x32_bf16 v[48:51], v[12:15], v[112:115], v[48:51]
    s_waitcnt lgkmcnt(2)
    v_mfma_f32_16x16x32_bf16 v[44:47], v[16:19], v[84:87], v[44:47]
    v_mfma_f32_16x16x32_bf16 v[48:51], v[16:19], v[116:119], v[48:51]
    s_waitcnt lgkmcnt(1)
    v_mfma_f32_16x16x32_bf16 v[44:47], v[20:23], v[88:91], v[44:47]
    v_mfma_f32_16x16x32_bf16 v[48:51], v[20:23], v[120:123], v[48:51]
    s_waitcnt lgkmcnt(0)
    v_mfma_f32_16x16x32_bf16 v[44:47], v[24:27], v[92:95], v[44:47]
    v_mfma_f32_16x16x32_bf16 v[48:51], v[24:27], v[124:127], v[48:51]
    ds_read_u16_d16_hi v20, v6 offset:0
    ds_read_u16_d16_hi v21, v61 offset:0
    ds_read_u16_d16_hi v22, v62 offset:0
    ds_read_u16_d16_hi v23, v63 offset:0
    ds_read_u16_d16_hi v24, v6 offset:2
    ds_read_u16_d16_hi v25, v61 offset:2
    ds_read_u16_d16_hi v26, v62 offset:2
    ds_read_u16_d16_hi v27, v63 offset:2
    v_mfma_f32_16x16x32_bf16 v[52:55], v[28:31], v[64:67], 0
    v_exp_f32 v12, v44
    v_mfma_f32_16x16x32_bf16 v[56:59], v[28:31], v[96:99], 0
    v_exp_f32 v13, v45
    v_mfma_f32_16x16x32_bf16 v[52:55], v[32:35], v[68:71], v[52:55]
    v_exp_f32 v14, v46
    v_mfma_f32_16x16x32_bf16 v[56:59], v[32:35], v[100:103], v[56:59]
    v_exp_f32 v15, v47
    v_exp_f32 v16, v48
    v_exp_f32 v17, v49
    v_exp_f32 v18, v50
    v_exp_f32 v19, v51
    v_pk_fma_f32 v[12:13], v[12:13], s[10:11], s[10:11]
    v_pk_fma_f32 v[14:15], v[14:15], s[10:11], s[10:11]
    v_pk_fma_f32 v[16:17], v[16:17], s[10:11], s[10:11]
    v_pk_fma_f32 v[18:19], v[18:19], s[10:11], s[10:11]
    v_mfma_f32_16x16x32_bf16 v[52:55], v[36:39], v[72:75], v[52:55]
    v_rcp_f32 v12, v12
    v_mfma_f32_16x16x32_bf16 v[56:59], v[36:39], v[104:107], v[56:59]
    v_rcp_f32 v13, v13
    v_mfma_f32_16x16x32_bf16 v[52:55], v[40:43], v[76:79], v[52:55]
    v_rcp_f32 v14, v14
    v_mfma_f32_16x16x32_bf16 v[56:59], v[40:43], v[108:111], v[56:59]
    v_rcp_f32 v15, v15
    v_rcp_f32 v16, v16
    v_rcp_f32 v17, v17
    v_rcp_f32 v18, v18
    v_rcp_f32 v19, v19
    s_waitcnt lgkmcnt(0)
    v_pk_fma_f32 v[20:21], v[44:45], v[12:13], v[20:21]
    v_pk_fma_f32 v[22:23], v[46:47], v[14:15], v[22:23]
    v_pk_fma_f32 v[24:25], v[48:49], v[16:17], v[24:25]
    v_pk_fma_f32 v[26:27], v[50:51], v[18:19], v[26:27]
    s_mov_b32 s5, 0
    v_cvt_pk_bf16_f32 v44, v20, v24
    buffer_store_dword v44, v7, s[52:55], s5 offen sc1
    s_mov_b32 s5, 524288
    v_cvt_pk_bf16_f32 v45, v21, v25
    buffer_store_dword v45, v7, s[52:55], s5 offen sc1
    s_mov_b32 s5, 1048576
    v_cvt_pk_bf16_f32 v46, v22, v26
    s_mov_b32 exec_lo, s12
    s_mov_b32 exec_hi, 0xffff
    buffer_store_dword v46, v7, s[52:55], s5 offen sc1
    s_mov_b32 s5, 1572864
    v_cvt_pk_bf16_f32 v47, v23, v27
    s_mov_b32 exec_lo, 0xffff
    buffer_store_dword v47, v7, s[52:55], s5 offen sc1
    s_mov_b64 exec, -1
    s_setprio 1
    ds_read_b128 v[28:31], v5 offset:8192
    ds_read_b128 v[32:35], v9 offset:8192
    ds_read_b128 v[36:39], v10 offset:8192
    ds_read_b128 v[40:43], v11 offset:8192
    s_bfe_u32 s5, s98, 0x10001
    s_lshl_b32 s5, s5, 13
    v_xad_u32 v8, v4, s5, v3
    s_mov_b32 s72, 0x1000000
L_sw1:
    ds_read_b32 v60, v1 offset:212
    s_waitcnt lgkmcnt(0)
    v_readfirstlane_b32 s5, v60
    s_cmp_ge_u32 s5, 4
    s_cbranch_scc1 L_sg1
    s_sleep 4
    s_sub_u32 s72, s72, 1
    s_cbranch_scc0 L_sw1
L_sg1:
    ds_read_b128 v[12:15], v8 offset:16384
    ds_read_b128 v[16:19], v8 offset:16448
    ds_read_b128 v[20:23], v8 offset:20480
    ds_read_b128 v[24:27], v8 offset:20544
    s_waitcnt lgkmcnt(3)
    v_mfma_f32_16x16x32_bf16 v[52:55], v[12:15], v[80:83], v[52:55]
    v_mfma_f32_16x16x32_bf16 v[56:59], v[12:15], v[112:115], v[56:59]
    s_waitcnt lgkmcnt(2)
    v_mfma_f32_16x16x32_bf16 v[52:55], v[16:19], v[84:87], v[52:55]
    v_mfma_f32_16x16x32_bf16 v[56:59], v[16:19], v[116:119], v[56:59]
    s_waitcnt lgkmcnt(1)
    v_mfma_f32_16x16x32_bf16 v[52:55], v[20:23], v[88:91], v[52:55]
    v_mfma_f32_16x16x32_bf16 v[56:59], v[20:23], v[120:123], v[56:59]
    s_waitcnt lgkmcnt(0)
    v_mfma_f32_16x16x32_bf16 v[52:55], v[24:27], v[92:95], v[52:55]
    v_mfma_f32_16x16x32_bf16 v[56:59], v[24:27], v[124:127], v[56:59]
    ds_read_u16_d16_hi v20, v6 offset:4096
    ds_read_u16_d16_hi v21, v61 offset:4096
    ds_read_u16_d16_hi v22, v62 offset:4096
    ds_read_u16_d16_hi v23, v63 offset:4096
    ds_read_u16_d16_hi v24, v6 offset:4098
    ds_read_u16_d16_hi v25, v61 offset:4098
    ds_read_u16_d16_hi v26, v62 offset:4098
    ds_read_u16_d16_hi v27, v63 offset:4098
    v_mfma_f32_16x16x32_bf16 v[44:47], v[28:31], v[64:67], 0
    v_exp_f32 v12, v52
    v_mfma_f32_16x16x32_bf16 v[48:51], v[28:31], v[96:99], 0
    v_exp_f32 v13, v53
    v_mfma_f32_16x16x32_bf16 v[44:47], v[32:35], v[68:71], v[44:47]
    v_exp_f32 v14, v54
    v_mfma_f32_16x16x32_bf16 v[48:51], v[32:35], v[100:103], v[48:51]
    v_exp_f32 v15, v55
    v_exp_f32 v16, v56
    v_exp_f32 v17, v57
    v_exp_f32 v18, v58
    v_exp_f32 v19, v59
    v_pk_fma_f32 v[12:13], v[12:13], s[10:11], s[10:11]
    v_pk_fma_f32 v[14:15], v[14:15], s[10:11], s[10:11]
    v_pk_fma_f32 v[16:17], v[16:17], s[10:11], s[10:11]
    v_pk_fma_f32 v[18:19], v[18:19], s[10:11], s[10:11]
    v_mfma_f32_16x16x32_bf16 v[44:47], v[36:39], v[72:75], v[44:47]
    v_rcp_f32 v12, v12
    v_mfma_f32_16x16x32_bf16 v[48:51], v[36:39], v[104:107], v[48:51]
    v_rcp_f32 v13, v13
    v_mfma_f32_16x16x32_bf16 v[44:47], v[40:43], v[76:79], v[44:47]
    v_rcp_f32 v14, v14
    v_mfma_f32_16x16x32_bf16 v[48:51], v[40:43], v[108:111], v[48:51]
    v_rcp_f32 v15, v15
    v_rcp_f32 v16, v16
    v_rcp_f32 v17, v17
    v_rcp_f32 v18, v18
    v_rcp_f32 v19, v19
    s_waitcnt lgkmcnt(0)
    v_pk_fma_f32 v[20:21], v[52:53], v[12:13], v[20:21]
    v_pk_fma_f32 v[22:23], v[54:55], v[14:15], v[22:23]
    v_pk_fma_f32 v[24:25], v[56:57], v[16:17], v[24:25]
    v_pk_fma_f32 v[26:27], v[58:59], v[18:19], v[26:27]
    s_mov_b32 s5, 131072
    v_cvt_pk_bf16_f32 v52, v20, v24
    buffer_store_dword v52, v7, s[52:55], s5 offen sc1
    s_mov_b32 s5, 655360
    v_cvt_pk_bf16_f32 v53, v21, v25
    buffer_store_dword v53, v7, s[52:55], s5 offen sc1
    s_mov_b32 s5, 1179648
    v_cvt_pk_bf16_f32 v54, v22, v26
    s_mov_b32 exec_lo, 0xffff
    s_mov_b32 exec_hi, 0xffff
    buffer_store_dword v54, v7, s[52:55], s5 offen sc1
    s_mov_b32 s5, 1703936
    v_cvt_pk_bf16_f32 v55, v23, v27
    buffer_store_dword v55, v7, s[52:55], s5 offen sc1
    s_mov_b64 exec, -1
    s_setprio 0
    ds_read_b128 v[28:31], v5 offset:12288
    ds_read_b128 v[32:35], v9 offset:12288
    ds_read_b128 v[36:39], v10 offset:12288
    ds_read_b128 v[40:43], v11 offset:12288
    s_bfe_u32 s5, s98, 0x10002
    s_lshl_b32 s5, s5, 13
    v_xad_u32 v8, v4, s5, v3
    s_mov_b32 s72, 0x1000000
L_sw2:
    ds_read_b32 v60, v1 offset:216
    s_waitcnt lgkmcnt(0)
    v_readfirstlane_b32 s5, v60
    s_cmp_ge_u32 s5, 4
    s_cbranch_scc1 L_sg2
    s_sleep 1
    s_sub_u32 s72, s72, 1
    s_cbranch_scc0 L_sw2
L_sg2:
    ds_read_b128 v[12:15], v8 offset:32768
    ds_read_b128 v[16:19], v8 offset:32832
    ds_read_b128 v[20:23], v8 offset:36864
    ds_read_b128 v[24:27], v8 offset:36928
    s_bfe_u32 s5, s98, 0x10003
    s_lshl_b32 s5, s5, 13
    v_xad_u32 v8, v4, s5, v3
    s_waitcnt lgkmcnt(3)
    v_mfma_f32_16x16x32_bf16 v[44:47], v[12:15], v[80:83], v[44:47]
    v_mfma_f32_16x16x32_bf16 v[48:51], v[12:15], v[112:115], v[48:51]
    s_waitcnt lgkmcnt(2)
    v_mfma_f32_16x16x32_bf16 v[44:47], v[16:19], v[84:87], v[44:47]
    v_mfma_f32_16x16x32_bf16 v[48:51], v[16:19], v[116:119], v[48:51]
    s_waitcnt lgkmcnt(1)
    v_mfma_f32_16x16x32_bf16 v[44:47], v[20:23], v[88:91], v[44:47]
    v_mfma_f32_16x16x32_bf16 v[48:51], v[20:23], v[120:123], v[48:51]
    s_waitcnt lgkmcnt(0)
    v_mfma_f32_16x16x32_bf16 v[44:47], v[24:27], v[92:95], v[44:47]
    v_mfma_f32_16x16x32_bf16 v[48:51], v[24:27], v[124:127], v[48:51]
    ds_read_u16_d16_hi v20, v6 offset:8192
    ds_read_u16_d16_hi v21, v61 offset:8192
    ds_read_u16_d16_hi v22, v62 offset:8192
    ds_read_u16_d16_hi v23, v63 offset:8192
    ds_read_u16_d16_hi v24, v6 offset:8194
    ds_read_u16_d16_hi v25, v61 offset:8194
    ds_read_u16_d16_hi v26, v62 offset:8194
    ds_read_u16_d16_hi v27, v63 offset:8194
    v_mfma_f32_16x16x32_bf16 v[52:55], v[28:31], v[64:67], 0
    v_exp_f32 v12, v44
    v_mfma_f32_16x16x32_bf16 v[56:59], v[28:31], v[96:99], 0
    v_exp_f32 v13, v45
    v_mfma_f32_16x16x32_bf16 v[52:55], v[32:35], v[68:71], v[52:55]
    v_exp_f32 v14, v46
    v_mfma_f32_16x16x32_bf16 v[56:59], v[32:35], v[100:103], v[56:59]
    v_exp_f32 v15, v47
    v_exp_f32 v16, v48
    v_exp_f32 v17, v49
    v_exp_f32 v18, v50
    v_exp_f32 v19, v51
    v_pk_fma_f32 v[12:13], v[12:13], s[10:11], s[10:11]
    v_pk_fma_f32 v[14:15], v[14:15], s[10:11], s[10:11]
    v_pk_fma_f32 v[16:17], v[16:17], s[10:11], s[10:11]
    v_pk_fma_f32 v[18:19], v[18:19], s[10:11], s[10:11]
    v_mfma_f32_16x16x32_bf16 v[52:55], v[36:39], v[72:75], v[52:55]
    v_rcp_f32 v12, v12
    v_mfma_f32_16x16x32_bf16 v[56:59], v[36:39], v[104:107], v[56:59]
    v_rcp_f32 v13, v13
    v_mfma_f32_16x16x32_bf16 v[52:55], v[40:43], v[76:79], v[52:55]
    v_rcp_f32 v14, v14
    v_mfma_f32_16x16x32_bf16 v[56:59], v[40:43], v[108:111], v[56:59]
    v_rcp_f32 v15, v15
    v_rcp_f32 v16, v16
    v_rcp_f32 v17, v17
    v_rcp_f32 v18, v18
    v_rcp_f32 v19, v19
    s_waitcnt lgkmcnt(0)
    ds_read_b32 v60, v1 offset:220
    ds_read_b128 v[28:31], v8 offset:49152
    ds_read_b128 v[32:35], v8 offset:49216
    ds_read_b128 v[36:39], v8 offset:53248
    ds_read_b128 v[40:43], v8 offset:53312
    v_pk_fma_f32 v[20:21], v[44:45], v[12:13], v[20:21]
    v_pk_fma_f32 v[22:23], v[46:47], v[14:15], v[22:23]
    v_pk_fma_f32 v[24:25], v[48:49], v[16:17], v[24:25]
    v_pk_fma_f32 v[26:27], v[50:51], v[18:19], v[26:27]
    s_mov_b32 s5, 262144
    v_cvt_pk_bf16_f32 v44, v20, v24
    buffer_store_dword v44, v7, s[52:55], s5 offen sc1
    s_mov_b32 s5, 786432
    v_cvt_pk_bf16_f32 v45, v21, v25
    buffer_store_dword v45, v7, s[52:55], s5 offen sc1
    s_mov_b32 s5, 1310720
    v_cvt_pk_bf16_f32 v46, v22, v26
    s_mov_b32 exec_lo, 0xffff
    s_mov_b32 exec_hi, 0xffff
    buffer_store_dword v46, v7, s[52:55], s5 offen sc1
    s_mov_b32 s5, 1835008
    v_cvt_pk_bf16_f32 v47, v23, v27
    buffer_store_dword v47, v7, s[52:55], s5 offen sc1
    s_mov_b64 exec, -1
    s_setprio 3
    s_mov_b32 s72, 0x1000000
L_sw3:
    s_waitcnt lgkmcnt(4)
    v_readfirstlane_b32 s5, v60
    s_cmp_ge_u32 s5, 4
    s_cbranch_scc1 L_sg3
    s_sleep 1
    ds_read_b32 v60, v1 offset:220
    ds_read_b128 v[28:31], v8 offset:49152
    ds_read_b128 v[32:35], v8 offset:49216
    ds_read_b128 v[36:39], v8 offset:53248
    ds_read_b128 v[40:43], v8 offset:53312
    s_sub_u32 s72, s72, 1
    s_cbranch_scc0 L_sw3
L_sg3:
    s_waitcnt lgkmcnt(3)
    v_mfma_f32_16x16x32_bf16 v[52:55], v[28:31], v[80:83], v[52:55]
    v_mfma_f32_16x16x32_bf16 v[56:59], v[28:31], v[112:115], v[56:59]
    s_waitcnt lgkmcnt(2)
    v_mfma_f32_16x16x32_bf16 v[52:55], v[32:35], v[84:87], v[52:55]
    v_mfma_f32_16x16x32_bf16 v[56:59], v[32:35], v[116:119], v[56:59]
    s_waitcnt lgkmcnt(1)
    v_mfma_f32_16x16x32_bf16 v[52:55], v[36:39], v[88:91], v[52:55]
    v_mfma_f32_16x16x32_bf16 v[56:59], v[36:39], v[120:123], v[56:59]
    s_waitcnt lgkmcnt(0)
    v_mfma_f32_16x16x32_bf16 v[52:55], v[40:43], v[92:95], v[52:55]
    v_mfma_f32_16x16x32_bf16 v[56:59], v[40:43], v[124:127], v[56:59]
    ds_read_u16_d16_hi v20, v6 offset:12288
    ds_read_u16_d16_hi v21, v61 offset:12288
    ds_read_u16_d16_hi v22, v62 offset:12288
    ds_read_u16_d16_hi v23, v63 offset:12288
    ds_read_u16_d16_hi v24, v6 offset:12290
    ds_read_u16_d16_hi v25, v61 offset:12290
    ds_read_u16_d16_hi v26, v62 offset:12290
    ds_read_u16_d16_hi v27, v63 offset:12290
    v_exp_f32 v12, v52
    v_exp_f32 v13, v53
    v_exp_f32 v14, v54
    v_exp_f32 v15, v55
    v_exp_f32 v16, v56
    v_exp_f32 v17, v57
    v_exp_f32 v18, v58
    v_exp_f32 v19, v59
    v_pk_fma_f32 v[12:13], v[12:13], s[10:11], s[10:11]
    v_pk_fma_f32 v[14:15], v[14:15], s[10:11], s[10:11]
    v_pk_fma_f32 v[16:17], v[16:17], s[10:11], s[10:11]
    v_pk_fma_f32 v[18:19], v[18:19], s[10:11], s[10:11]
    v_rcp_f32 v12, v12
    v_rcp_f32 v13, v13
    v_rcp_f32 v14, v14
    v_rcp_f32 v15, v15
    v_rcp_f32 v16, v16
    v_rcp_f32 v17, v17
    v_rcp_f32 v18, v18
    v_rcp_f32 v19, v19
    s_waitcnt lgkmcnt(0)
    v_pk_fma_f32 v[20:21], v[52:53], v[12:13], v[20:21]
    v_pk_fma_f32 v[22:23], v[54:55], v[14:15], v[22:23]
    v_pk_fma_f32 v[24:25], v[56:57], v[16:17], v[24:25]
    v_pk_fma_f32 v[26:27], v[58:59], v[18:19], v[26:27]
    s_mov_b32 s5, 393216
    v_cvt_pk_bf16_f32 v52, v20, v24
    buffer_store_dword v52, v7, s[52:55], s5 offen sc1
    s_mov_b32 s5, 917504
    v_cvt_pk_bf16_f32 v53, v21, v25
    buffer_store_dword v53, v7, s[52:55], s5 offen sc1
    s_mov_b32 s5, 1441792
    v_cvt_pk_bf16_f32 v54, v22, v26
    s_mov_b32 exec_lo, 0xffff
    s_mov_b32 exec_hi, 0xffff
    buffer_store_dword v54, v7, s[52:55], s5 offen sc1
    s_mov_b32 s5, 1966080
    v_cvt_pk_bf16_f32 v55, v23, v27
    buffer_store_dword v55, v7, s[52:55], s5 offen sc1
    s_mov_b64 exec, -1
L_exit:
    s_lshl_b32 s5, s2, 4
    s_add_u32 s5, s5, s4
    s_cmp_lg_u32 s5, 4
    s_cbranch_scc1 L_exit2
    v_mov_b32 v1, 0
    v_mov_b32 v2, s60
    s_mov_b64 exec, 1
    buffer_store_dword v2, v1, s[40:43], 0 offen sc1
L_exit2:
L_end:
    s_endpgm
L_rp:
    s_cmp_lt_i32 s16, 0
    s_cbranch_scc1 L_slow
    s_mov_b32 s72, 0x100000
L_rp1:
    s_mov_b64 exec, vcc
    buffer_load_dwordx4 v[64:67], v49, s[40:43], s73 offen sc1
    s_waitcnt vmcnt(0)
    v_bfi_b32 v56, s8, v64, v65
    v_bfi_b32 v57, s8, v66, v67
    v_bitop3_b32 v56, v56, v57, s75 bitop3:0x7e
    v_and_b32 v56, 0xffc0fff0, v56
    v_cmp_ne_u32 vcc, 0, v56
    s_mov_b64 exec, -1
    s_sub_u32 s72, s72, 1
    s_cbranch_scc1 L_rpd
    s_cmp_lg_u64 vcc, 0
    s_cbranch_scc1 L_rp1
    s_branch L_rpd
L_slow:
    v_mov_b32 v53, v3
    s_mov_b32 exec_lo, 0
    ds_read_b128 v[24:27], v53
    ds_read_b128 v[28:31], v53 offset:4096
    s_not_b64 exec, exec
    ds_read_b32 v24, v41 offset:54784
    ds_read_b32 v28, v41 offset:54912
    s_mov_b64 exec, -1
    v_mov_b64 v[96:97], 0
    v_mov_b64 v[98:99], 0
    v_mov_b64 v[100:101], 0
    v_mov_b64 v[102:103], 0
    v_mov_b64 v[104:105], 0
    v_mov_b64 v[106:107], 0
    v_mov_b64 v[108:109], 0
    v_mov_b64 v[110:111], 0
    v_mov_b64 v[112:113], 0
    v_mov_b64 v[114:115], 0
    v_mov_b64 v[116:117], 0
    v_mov_b64 v[118:119], 0
    v_mov_b64 v[120:121], 0
    v_mov_b64 v[122:123], 0
    v_mov_b64 v[124:125], 0
    v_mov_b64 v[126:127], 0
    s_mov_b32 s101, 1
    v_lshrrev_b32 v40, 2, v1
    buffer_load_dword v43, v42, s[40:43], 0 offen sc1
    s_mov_b32 s72, 0x100000
L_fs:
    s_waitcnt vmcnt(0)
L_fsc:
    v_cmp_ne_u32 vcc, s60, v43
    s_sub_u32 s72, s72, 1
    s_cbranch_scc1 L_fsd
    s_and_b64 exec, exec, vcc
    s_cbranch_execz L_fsd
    buffer_load_dword v43, v42, s[40:43], 0 offen sc1
    s_branch L_fs
L_fsd:
    s_mov_b64 exec, -1
    s_lshl_b32 s5, s3, 4
    s_add_u32 s5, s5, 1048576
    v_lshl_add_u32 v41, v40, 12, s5
    buffer_load_dword v44, v41, s[40:43], 0 offen sc1
    v_and_b32 v46, 3, v0
    v_lshlrev_b32 v46, 1, v46
    v_mul_u32_u24 v40, 0x3100, v40
    s_waitcnt vmcnt(0)
    v_and_b32 v47, 0x7ff, v44
    v_add_lshl_u32 v47, v47, v46, 3
    v_add_u32 v1, v40, v47
    v_bfe_u32 v47, v44, 16, 11
    v_sub_u32 v47, v47, v46
    v_lshlrev_b32 v2, 8, v47
L_round:
    v_ashrrev_i32 v40, 8, v2
    v_cmp_lt_i32 vcc, 0, v40
    s_and_b64 exec, exec, vcc
    s_cbranch_execz L_rl
    buffer_load_dwordx4 v[64:67], v1, s[40:43], s73 offen offset:0 sc1
    v_cmp_lt_i32 vcc, 8, v40
    s_and_b64 exec, exec, vcc
    s_cbranch_execz L_rl
    buffer_load_dwordx4 v[68:71], v1, s[40:43], s73 offen offset:64 sc1
    v_cmp_lt_i32 vcc, 16, v40
    s_and_b64 exec, exec, vcc
    s_cbranch_execz L_rl
    buffer_load_dwordx4 v[72:75], v1, s[40:43], s73 offen offset:128 sc1
L_rl:
    s_mov_b64 exec, -1
    v_mov_b32 v41, 1
    s_waitcnt lgkmcnt(0)
    s_barrier
    s_waitcnt vmcnt(0)
    v_and_b32 v42, 1, v2
    v_cmp_lt_i32 vcc, 0, v40
    v_cmp_eq_u32 s[68:69], 0, v42
    v_mov_b32 v80, -1
    v_bfe_u32 v86, v64, 16, 3
    s_and_b64 exec, vcc, s[68:69]
    v_lshlrev_b32 v42, 2, v86
    ds_add_rtn_u32 v80, v42, v41 offset:160
    s_mov_b64 exec, -1
    v_and_b32 v42, 2, v2
    v_cmp_lt_i32 vcc, 1, v40
    v_cmp_eq_u32 s[68:69], 0, v42
    v_mov_b32 v81, -1
    v_bfe_u32 v87, v66, 16, 3
    s_and_b64 exec, vcc, s[68:69]
    v_lshlrev_b32 v42, 2, v87
    ds_add_rtn_u32 v81, v42, v41 offset:160
    s_mov_b64 exec, -1
    v_and_b32 v42, 4, v2
    v_cmp_lt_i32 vcc, 8, v40
    v_cmp_eq_u32 s[68:69], 0, v42
    v_mov_b32 v82, -1
    v_bfe_u32 v88, v68, 16, 3
    s_and_b64 exec, vcc, s[68:69]
    v_lshlrev_b32 v42, 2, v88
    ds_add_rtn_u32 v82, v42, v41 offset:160
    s_mov_b64 exec, -1
    v_and_b32 v42, 8, v2
    v_cmp_lt_i32 vcc, 9, v40
    v_cmp_eq_u32 s[68:69], 0, v42
    v_mov_b32 v83, -1
    v_bfe_u32 v89, v70, 16, 3
    s_and_b64 exec, vcc, s[68:69]
    v_lshlrev_b32 v42, 2, v89
    ds_add_rtn_u32 v83, v42, v41 offset:160
    s_mov_b64 exec, -1
    v_and_b32 v42, 16, v2
    v_cmp_lt_i32 vcc, 16, v40
    v_cmp_eq_u32 s[68:69], 0, v42
    v_mov_b32 v84, -1
    v_bfe_u32 v90, v72, 16, 3
    s_and_b64 exec, vcc, s[68:69]
    v_lshlrev_b32 v42, 2, v90
    ds_add_rtn_u32 v84, v42, v41 offset:160
    s_mov_b64 exec, -1
    v_and_b32 v42, 32, v2
    v_cmp_lt_i32 vcc, 17, v40
    v_cmp_eq_u32 s[68:69], 0, v42
    v_mov_b32 v85, -1
    v_bfe_u32 v91, v74, 16, 3
    s_and_b64 exec, vcc, s[68:69]
    v_lshlrev_b32 v42, 2, v91
    ds_add_rtn_u32 v85, v42, v41 offset:160
    s_mov_b64 exec, -1
    s_movk_i32 s5, 352
    s_waitcnt lgkmcnt(5)
    v_cmp_gt_u32 vcc, s5, v80
    v_mad_u32_u24 v42, v86, s5, v80
    v_lshlrev_b32 v42, 4, v42
    s_mov_b64 exec, vcc
    ds_write_b64 v42, v[64:65] offset:8960
    v_or_b32 v2, 1, v2
    s_mov_b64 exec, -1
    v_add_u32 v80, 1, v80
    s_waitcnt lgkmcnt(5)
    v_cmp_gt_u32 vcc, s5, v81
    v_mad_u32_u24 v42, v87, s5, v81
    v_lshlrev_b32 v42, 4, v42
    s_mov_b64 exec, vcc
    ds_write_b64 v42, v[66:67] offset:8960
    v_or_b32 v2, 2, v2
    s_mov_b64 exec, -1
    v_add_u32 v81, 1, v81
    s_waitcnt lgkmcnt(5)
    v_cmp_gt_u32 vcc, s5, v82
    v_mad_u32_u24 v42, v88, s5, v82
    v_lshlrev_b32 v42, 4, v42
    s_mov_b64 exec, vcc
    ds_write_b64 v42, v[68:69] offset:8960
    v_or_b32 v2, 4, v2
    s_mov_b64 exec, -1
    v_add_u32 v82, 1, v82
    s_waitcnt lgkmcnt(5)
    v_cmp_gt_u32 vcc, s5, v83
    v_mad_u32_u24 v42, v89, s5, v83
    v_lshlrev_b32 v42, 4, v42
    s_mov_b64 exec, vcc
    ds_write_b64 v42, v[70:71] offset:8960
    v_or_b32 v2, 8, v2
    s_mov_b64 exec, -1
    v_add_u32 v83, 1, v83
    s_waitcnt lgkmcnt(5)
    v_cmp_gt_u32 vcc, s5, v84
    v_mad_u32_u24 v42, v90, s5, v84
    v_lshlrev_b32 v42, 4, v42
    s_mov_b64 exec, vcc
    ds_write_b64 v42, v[72:73] offset:8960
    v_or_b32 v2, 16, v2
    s_mov_b64 exec, -1
    v_add_u32 v84, 1, v84
    s_waitcnt lgkmcnt(5)
    v_cmp_gt_u32 vcc, s5, v85
    v_mad_u32_u24 v42, v91, s5, v85
    v_lshlrev_b32 v42, 4, v42
    s_mov_b64 exec, vcc
    ds_write_b64 v42, v[74:75] offset:8960
    v_or_b32 v2, 32, v2
    s_mov_b64 exec, -1
    v_add_u32 v85, 1, v85
    v_max3_u32 v42, v80, v81, v82
    v_max3_u32 v42, v42, v83, v84
    v_max_u32 v42, v42, v85
    v_cmp_ge_u32 vcc, s5, v42
    v_add_u32 v43, 0xc0, v1
    v_add_u32 v44, 0xffffffe8, v40
    v_lshlrev_b32 v44, 8, v44
    v_cndmask_b32 v1, v1, v43, vcc
    v_mov_b32 v45, 0
    v_cndmask_b32 v2, v2, v44, vcc
    v_cmp_lt_i32 vcc, 0xff, v2
    s_mov_b64 exec, vcc
    ds_write_b32 v45, v41 offset:192
    s_mov_b64 exec, -1
    s_lshl_b32 s5, s61, 2
    v_mov_b32 v42, s5
    s_waitcnt lgkmcnt(0)
    s_barrier
    ds_read_b32 v43, v42 offset:160
    ds_read_b32 v44, v45 offset:192
    s_lshl_b32 s5, s62, 6
    v_add_u32 v40, s5, v0
    s_mul_i32 s6, s61, 352
    s_add_u32 s6, s6, 560
    v_add_lshl_u32 v41, v40, s6, 4
    s_mov_b32 s31, 88064
    s_waitcnt lgkmcnt(0)
    v_readfirstlane_b32 s64, v43
    v_readfirstlane_b32 s67, v44
    s_min_u32 s64, s64, 352
L_geo:
    v_cmp_gt_u32 vcc, s64, v40
    s_mov_b64 exec, vcc
    s_cbranch_execz L_geod
    ds_read_b64 v[64:65], v41
    s_waitcnt lgkmcnt(0)
    v_and_b32 v75, 0x3fff, v64
    v_mad_u32_u24 v76, v75, 6, s31
    v_bfe_u32 v77, v64, 16, 6
    ds_read_u16_d16_hi v68, v76
    ds_read_u16_d16_hi v69, v76 offset:2
    ds_read_u16_d16_hi v70, v76 offset:4
    v_lshlrev_b32 v76, 3, v77
    ds_read_b64 v[72:73], v76 offset:54272
    v_lshrrev_b32 v77, 3, v77
    v_and_b32 v74, 0xffff0000, v65
    v_lshl_or_b32 v49, v77, 20, v75
    v_mul_f32 v74, 0xbfb8aa3b, v74
    s_waitcnt lgkmcnt(0)
    v_lshlrev_b32 v75, 16, v72
    v_and_b32 v72, 0xffff0000, v72
    v_sub_f32 v70, v73, v70
    v_sub_f32 v68, v75, v68
    v_sub_f32 v69, v72, v69
    v_mul_f32 v72, v70, v70
    v_fmac_f32 v72, v68, v68
    v_cvt_pk_bf16_f32 v50, 1.0, v68
    v_fmac_f32 v72, v69, v69
    v_cvt_pk_bf16_f32 v51, v69, v70
    v_mul_f32 v72, 0xbfb8aa3b, v72
    v_cvt_pk_bf16_f32 v48, v72, v74
    ds_write_b128 v41, v[48:51]
    v_add_u32 v40, 0x80, v40
    v_add_u32 v41, 0x800, v41
    s_branch L_geo
L_geod:
    s_mov_b64 exec, -1
    s_mul_i32 s6, s61, 5632
    s_add_u32 s6, s6, 8960
    v_lshrrev_b32 v56, 5, v0
    v_and_b32 v57, 31, v0
    v_lshrrev_b32 v58, 1, v57
    v_xor_b32 v58, v58, v57
    v_and_b32 v58, 2, v58
    v_mul_u32_u24 v58, 3, v58
    v_xor_b32 v58, v58, v57
    v_lshl_add_u32 v6, v58, 4, s6
    v_bfe_u32 v58, v0, 2, 2
    v_and_b32 v63, 2, v58
    v_add_u32 v58, v58, v63
    v_lshl_add_u32 v58, v56, 1, v58
    v_lshl_add_u32 v9, v58, 4, s6
    v_lshrrev_b32 v63, 3, v0
    v_lshrrev_b32 v58, 1, v63
    v_xor_b32 v58, v58, v63
    v_and_b32 v58, 2, v58
    v_mul_u32_u24 v58, 3, v58
    v_xor_b32 v58, v58, v63
    v_lshl_add_u32 v7, v58, 4, s6
    v_mov_b32 v44, 0
    v_mov_b32 v45, 0x3fff
    v_mov_b64 v[46:47], 0
    s_add_u32 s65, s64, 31
    s_lshr_b32 s65, s65, 5
    s_lshl_b32 s7, s65, 5
    s_sub_u32 s7, s7, s64
    s_mul_i32 s6, s61, 352
    s_add_u32 s6, s6, s64
    s_add_u32 s6, s6, 560
    v_add_lshl_u32 v59, v0, s6, 4
    s_bfm_b64 exec, s7, 0
    ds_write_b128 v59, v[44:47]
    s_mov_b64 exec, -1
    v_bfe_u32 v56, v0, 4, 1
    v_and_b32 v57, 3, v0
    v_lshl_add_u32 v56, v56, 2, v57
    v_lshlrev_b32 v8, 20, v56
    v_mov_b64 v[36:37], 0
    v_mov_b64 v[38:39], 0
    s_mov_b32 m0, s66
    s_branch L_go0
L_empty:
    s_waitcnt lgkmcnt(0)
    s_branch L_done
L_one:
    s_nop 7
    s_branch L_last
L_again:
    s_mov_b32 s101, 1
    s_barrier
    v_lshlrev_b32 v40, 2, v0
    v_mov_b32 v41, 0
    s_mov_b64 exec, 0x1ff
    ds_write_b32 v40, v41 offset:160
    s_mov_b64 exec, -1
    s_min_u32 s7, s4, 14
    s_mul_i32 s7, s7, 5
    s_lshl_b32 s7, s7, 10
    v_lshl_add_u32 v42, v0, 4, s7
    s_add_u32 s7, s7, 88064
    s_mov_b32 m0, s7
    s_nop 0
    buffer_load_dwordx4 v42, s[36:39], 0 offen offset:0 lds
    buffer_load_dwordx4 v42, s[36:39], 0 offen offset:1024 lds
    buffer_load_dwordx4 v42, s[36:39], 0 offen offset:2048 lds
    buffer_load_dwordx4 v42, s[36:39], 0 offen offset:3072 lds
    s_add_u32 m0, s7, 4096
    v_add_u32 v42, 0x1000, v42
    buffer_load_dwordx4 v42, s[36:39], 0 offen offset:0 lds
    s_branch L_round
L_codeend:
.section .rodata,"a"
.p2align 6
.amdhsa_kernel gather_scatter__cheap_equivariant_egnn__graph_kernel
  .amdhsa_next_free_vgpr 128
  .amdhsa_next_free_sgpr 102
  .amdhsa_accum_offset 128
  .amdhsa_group_segment_fixed_size 0
  .amdhsa_kernarg_size 88
  .amdhsa_user_sgpr_count 2
  .amdhsa_user_sgpr_kernarg_segment_ptr 1
  .amdhsa_system_sgpr_workgroup_id_x 1
  .amdhsa_float_denorm_mode_32 3
.end_amdhsa_kernel
```
